```python
import torch

def _softmax(x, axis=-1):
    return torch.softmax(x, dim=axis)
def _gelu(x):
    return torch.nn.functional.gelu(x, approximate="tanh")
def _silu(x):
    return torch.nn.functional.silu(x)
def _sigmoid(x):
    return torch.sigmoid(x)
def _layernorm(x, axis=-1, eps=1e-5):
    m = x.mean(dim=axis, keepdim=True)
    v = x.var(dim=axis, keepdim=True, unbiased=False)
    return (x - m) / torch.sqrt(v + eps)
def _scatter_add(tgt, idx, src, axis=0):
    return tgt.clone().index_add_(axis, idx, src)
def _segment_sum(src, seg, n):
    out = torch.zeros((n,) + src.shape[1:], dtype=src.dtype)
    return out.index_add_(0, seg, src)
def _pad(x, pw):
    flat = tuple(v for pair in reversed(pw) for v in pair)
    return torch.nn.functional.pad(x, flat)

kernel_name = 'recurrent_scan__spectral_fnet__mixer_s_mlp__prompt'

def setup_inputs():

    _w = (lambda a: (lambda t: t.to(torch.bfloat16) if t.is_floating_point() else t)(torch.as_tensor(a)))
    def _A_setup():
        B, S, D = 1, 2048, 512
        ns = torch.arange(S)[:, None] * torch.arange(S)[None, :]
        nd = torch.arange(D)[:, None] * torch.arange(D)[None, :]
        Ws_re = torch.cos(-2.0 * torch.pi * ns / S).to(float)
        Ws_im = torch.sin(-2.0 * torch.pi * ns / S).to(float)
        Wd_re = torch.cos(-2.0 * torch.pi * nd / D).to(float)
        Wd_im = torch.sin(-2.0 * torch.pi * nd / D).to(float)
        return {
            "x": _w((lambda *s: torch.randn(*s, dtype=torch.bfloat16) * 0.05)(B, S, D)),
            "dft_seq_re": _w(Ws_re),
            "dft_seq_im": _w(Ws_im),
            "dft_hid_re": _w(Wd_re),
            "dft_hid_im": _w(Wd_im),
        }
    _A_in = _A_setup()

    def _B_setup():
        B, S, D, F = 1, 2048, 512, 1792
        return {
            "x":  _w((lambda *s: torch.randn(*s, dtype=torch.bfloat16) * 0.05)(B, S, D)),
            "w1": _w((lambda *s: torch.randn(*s, dtype=torch.bfloat16) * 3.2)(D, D) * (D ** -0.5)),
            "w2": _w((lambda *s: torch.randn(*s, dtype=torch.bfloat16) * 3.2)(D, D) * (D ** -0.5)),
            "w3": _w((lambda *s: torch.randn(*s, dtype=torch.bfloat16) * 3.2)(D, F) * (D ** -0.5)),
            "w4": _w((lambda *s: torch.randn(*s, dtype=torch.bfloat16) * 1.6)(F, D) * (F ** -0.5)),
        }
    _B_in = _B_setup()

    return {
        "A_x": _A_in["x"],
        "A_dft_seq_re": _A_in["dft_seq_re"],
        "A_dft_seq_im": _A_in["dft_seq_im"],
        "A_dft_hid_re": _A_in["dft_hid_re"],
        "A_dft_hid_im": _A_in["dft_hid_im"],
        "B_x": _B_in["x"],
        "B_w1": _B_in["w1"],
        "B_w2": _B_in["w2"],
        "B_w3": _B_in["w3"],
        "B_w4": _B_in["w4"],
    }

def reference(A_x, A_dft_seq_re, A_dft_seq_im, A_dft_hid_re, A_dft_hid_im, B_x, B_w1, B_w2, B_w3, B_w4):
    def _A_ref(x, dft_seq_re, dft_seq_im, dft_hid_re, dft_hid_im):
        a = torch.einsum("bsd,ed->bse", x, dft_hid_re)
        b = torch.einsum("bsd,ed->bse", x, dft_hid_im)
        y = torch.einsum("ts,bse->bte", dft_seq_re, a) - torch.einsum("ts,bse->bte", dft_seq_im, b)
        return y

    def _B_ref(x, w1, w2, w3, w4):
        B, S, D = x.shape
        h = _gelu(_layernorm(x, axis=-1) @ w1)
        c = D // 4
        g0 = _pad(h[:, :, 0*c:1*c], ((0, 0), (1, 0), (0, 0)))[:, :S, :]
        g1 = _pad(h[:, :, 1*c:2*c], ((0, 0), (0, 1), (0, 0)))[:, 1:, :]
        g2 = _pad(h[:, :, 2*c:3*c], ((0, 0), (2, 0), (0, 0)))[:, :S, :]
        g3 = _pad(h[:, :, 3*c:   ], ((0, 0), (0, 2), (0, 0)))[:, 2:, :]
        hs = torch.concatenate([g0, g1, g2, g3], axis=-1) @ w2
        x1 = x + hs
        h2 = _gelu(_layernorm(x1, axis=-1) @ w3) @ w4
        return x1 + h2

    x = A_x
    xn = _layernorm(x, axis=-1)
    s = _A_ref(xn, A_dft_seq_re, A_dft_seq_im, A_dft_hid_re, A_dft_hid_im)
    g = _silu(_B_ref(xn, B_w1, B_w2, B_w3, B_w4))
    return x + s * g
```

```asm
; @launch grid=(256,1,1) block=(256,1,1) lds=163840
.amdgcn_target "amdgcn-amd-amdhsa--gfx950"
.text
.globl recurrent_scan__spectral_fnet__mixer_s_mlp__prompt_kernel
.p2align 12
.fill 192, 4, 0xbf810000
.p2align 8
.type recurrent_scan__spectral_fnet__mixer_s_mlp__prompt_kernel,@function
recurrent_scan__spectral_fnet__mixer_s_mlp__prompt_kernel:
  s_load_dwordx2 s[12:13], s[0:1], 48
  s_load_dwordx2 s[8:9], s[0:1], 0
  s_lshr_b32 s51, s2, 3
  s_cmp_ge_u32 s51, 32
  s_cbranch_scc1 L_end
  s_getpc_b64 s[4:5]
L_pc:
  v_lshlrev_b32 v16, 2, v0
  v_lshl_add_u32 v16, s51, 10, v16
  v_mov_b32 v17, s5
  v_add_co_u32 v16, vcc, s4, v16
  v_lshrrev_b32 v1, 6, v0
  v_and_b32 v0, 63, v0
  v_addc_co_u32 v17, vcc, 0, v17, vcc
  v_readfirstlane_b32 s38, v1
  global_load_dword v31, v[16:17], off
  s_and_b32 s37, s51, 7
  s_lshr_b32 s47, s2, 6
  s_add_u32 s59, s47, s37
  s_and_b32 s59, s59, 3
  v_lshrrev_b32 v16, 3, v0
  v_lshrrev_b32 v18, 5, v0
  v_and_b32 v19, 7, v0
  s_lshl_b32 s3, s38, 12
  s_lshr_b32 s39, s38, 1
  s_and_b32 s40, s38, 1
  s_and_b32 s48, s2, 7
  s_lshl_b32 s49, s48, 1
  s_add_u32 s36, s49, s47
  s_sub_u32 s49, s47, s49
  s_add_u32 s49, s49, 29
  s_cmp_lt_u32 s47, 2
  s_cselect_b32 s36, s36, s49
  s_cmp_eq_u32 s36, 32
  s_cselect_b32 s36, 16, s36
  s_lshl_b32 s54, s39, 5
  s_add_u32 s54, s54, s36
  v_lshl_add_u32 v22, s40, 4, v16
  v_lshlrev_b32 v22, 16, v22
  v_lshl_add_u32 v22, s54, 10, v22
  v_lshrrev_b32 v23, 1, v16
  v_xor_b32 v23, v23, v19
  v_lshl_add_u32 v20, v23, 4, v22
  v_xor_b32 v21, 64, v20
  v_add_u32 v21, 523264, v21
  s_lshr_b32 s52, s3, 1
  s_add_u32 s52, s52, 98304
  s_lshl_b32 s77, s59, 7
  s_mov_b32 s10, 0x200000
  s_mov_b32 s11, 0x20000
  s_waitcnt lgkmcnt(0)
  s_add_u32 m0, s52, 0
  s_nop 0
  buffer_load_dwordx4 v20, s[8:11], s77 offen lds
  v_and_or_b32 v17, v16, 2, v18
  v_lshlrev_b32 v17, 1, v17
  v_xor_b32 v17, v17, v19
  buffer_load_dwordx4 v21, s[8:11], s77 offen offset:1024 lds
  v_lshlrev_b32 v17, 4, v17
  v_lshl_add_u32 v22, v16, 10, v17
  v_lshl_add_u32 v2, s37, 7, v22
  s_movk_i32 s48, 7168
  s_add_u32 m0, s52, 8192
  s_xor_b32 s53, s77, 512
  buffer_load_dwordx4 v20, s[8:11], s53 offen lds
  s_lshl1_add_u32 s76, s59, s40
  s_lshl3_add_u32 s76, s39, s76
  v_add_u32 v3, s48, v2
  buffer_load_dwordx4 v21, s[8:11], s53 offen offset:1024 lds
  v_add_u32 v4, s48, v3
  v_add_u32 v5, s48, v4
  s_mov_b32 s14, 0x80000
  s_mov_b32 s15, 0x20000
  s_mov_b32 m0, s3
  s_lshl_b32 s53, s76, 15
  buffer_load_dwordx4 v2, s[12:15], s53 offen offset:0 lds
  s_load_dwordx2 s[16:17], s[0:1], 56
  s_load_dwordx2 s[32:33], s[0:1], 96
  s_load_dwordx2 s[20:21], s[0:1], 64
  s_load_dwordx2 s[24:25], s[0:1], 72
  s_load_dwordx2 s[28:29], s[0:1], 80
  s_mov_b32 s34, 0x10000000
  s_mov_b32 s35, 0x20000
  s_mov_b32 s18, 0x80000
  s_mov_b32 s19, 0x20000
  buffer_load_dwordx4 v3, s[12:15], s53 offen offset:1024 lds
  s_mov_b32 s22, 0x1c0000
  s_mov_b32 s23, 0x20000
  s_mov_b32 s26, 0x1c0000
  s_mov_b32 s27, 0x20000
  s_mov_b32 s30, 0x200000
  s_mov_b32 s31, 0x20000
  s_lshl2_add_u32 s51, s51, s38
  s_lshr_b32 s47, s2, 6
  s_cmp_gt_u32 s37, 3
  s_addc_u32 s47, s47, 0
  s_lshl_b32 s47, s47, 3
  s_sub_u32 s47, s2, s47
  s_lshl2_add_u32 s47, s47, s38
  s_mul_i32 s48, s47, 384
  s_add_u32 s48, s48, 1048448
  s_mul_i32 s49, s47, 640
  s_lshl_b32 s47, s47, 11
  s_cmp_eq_u32 s37, 3
  s_cselect_b32 s47, 0x7f000000, s47
  s_cselect_b32 s48, 0x7f000000, s48
  s_cselect_b32 s49, 0x7f000000, s49
  v_lshrrev_b32 v24, 2, v0
  buffer_load_dwordx4 v4, s[12:15], s53 offen offset:2048 lds
  v_lshl_add_u32 v232, v24, 7, s47
  v_lshrrev_b32 v24, 4, v0
  v_cmp_gt_u32 vcc, 16, v0
  v_lshl_add_u32 v24, v24, 7, s48
  s_nop 0
  v_cndmask_b32 v6, v24, 0, vcc
  s_mul_i32 s51, s51, 14
  v_lshrrev_b32_e64 v24, 2, v0
  v_add_lshl_u32 v234, v24, s51, 10
  v_bfe_u32 v24, v0, 2, 2
  buffer_load_dwordx4 v5, s[12:15], s53 offen offset:3072 lds
  v_bfe_u32 v25, v0, 5, 1
  v_lshl_add_u32 v25, v25, 3, v24
  v_bfe_u32 v26, v0, 4, 1
  v_and_or_b32 v26, v24, 2, v26
  v_lshlrev_b32 v26, 5, v26
  v_and_b32 v24, 3, v0
  v_lshl_add_u32 v26, v24, 3, v26
  v_lshl_add_u32 v48, v25, 7, v26
  s_lshl_b32 s51, s40, 6
  s_add_u32 m0, s52, 16384
  s_add_u32 s77, s77, 128
  buffer_load_dwordx4 v20, s[8:11], s77 offen lds
  v_xor_b32 v48, s51, v48
  v_xor_b32 v49, 32, v48
  v_add_u32 v49, 512, v49
  s_xor_b32 s78, s39, s40
  v_lshl_add_u32 v48, s78, 13, v48
  v_xor_b32 v50, 0x2000, v48
  v_lshl_add_u32 v49, s78, 13, v49
  v_xor_b32 v51, 0x2000, v49
  v_and_b32 v22, 31, v0
  buffer_load_dwordx4 v21, s[8:11], s77 offen offset:1024 lds
  v_bfe_u32 v23, v0, 1, 3
  v_xor_b32 v23, v23, v18
  v_lshlrev_b32 v23, 4, v23
  v_lshl_add_u32 v24, v22, 7, v23
  s_lshl1_add_u32 s47, s78, s39
  s_lshl_b32 s47, s47, 12
  s_add_u32 s47, s47, 98304
  v_add_u32 v52, s47, v24
  v_xor_b32 v53, 32, v52
  s_add_u32 m0, s52, 24576
  s_xor_b32 s53, s77, 512
  buffer_load_dwordx4 v20, s[8:11], s53 offen lds
  v_xor_b32 v54, 64, v52
  v_xor_b32 v55, 96, v52
  v_xor_b32 v56, 0x2000, v52
  v_xor_b32 v57, 0x2000, v53
  v_xor_b32 v58, 0x2000, v54
  v_xor_b32 v59, 0x2000, v55
  s_mov_b32 s44, 0x3f803f80
  v_mov_b32 v28, 0
  v_mov_b32 v29, 0
  buffer_load_dwordx4 v21, s[8:11], s53 offen offset:1024 lds
  v_mov_b32 v30, 0
  v_lshl_add_u32 v24, s37, 5, v22
  v_mov_b32 v25, 0x100
  v_cmp_eq_u32 vcc, 0, v24
  s_mul_i32 s50, s40, 0x3e800000
  s_lshl2_add_u32 s49, s78, s59
  s_lshl_b32 s49, s49, 6
  v_cndmask_b32 v24, v24, v25, vcc
  v_lshl_add_u32 v25, v18, 3, s49
  v_cvt_f32_u32 v24, v24
  v_cvt_f32_u32 v25, v25
  v_mul_f32 v24, 0x3b000000, v24
  v_fma_f32 v25, v25, v24, s50
  v_mul_f32 v26, 0x41800000, v24
  v_fract_f32 v25, v25
  v_cos_f32 v26, v26
  v_mov_b32 v247, v24
  v_mov_b32 v250, v25
  v_add_f32 v248, v26, v26
  v_cos_f32 v192, v250
  v_fmamk_f32 v193, v247, 0x3f800000, v250
  v_cos_f32 v193, v193
  v_fmamk_f32 v194, v247, 0x40000000, v250
  v_cos_f32 v194, v194
  v_fmamk_f32 v195, v247, 0x40400000, v250
  v_cos_f32 v195, v195
  v_fmamk_f32 v196, v247, 0x40800000, v250
  v_cos_f32 v196, v196
  v_fmamk_f32 v197, v247, 0x40a00000, v250
  v_cos_f32 v197, v197
  v_fmamk_f32 v198, v247, 0x40c00000, v250
  v_cos_f32 v198, v198
  v_fmamk_f32 v199, v247, 0x40e00000, v250
  v_cos_f32 v199, v199
  v_fmamk_f32 v200, v247, 0x41800000, v250
  v_cos_f32 v200, v200
  v_fmamk_f32 v201, v247, 0x41880000, v250
  v_cos_f32 v201, v201
  v_fmamk_f32 v202, v247, 0x41900000, v250
  v_cos_f32 v202, v202
  v_fmamk_f32 v203, v247, 0x41980000, v250
  v_cos_f32 v203, v203
  v_fmamk_f32 v204, v247, 0x41a00000, v250
  v_cos_f32 v204, v204
  v_fmamk_f32 v205, v247, 0x41a80000, v250
  v_cos_f32 v205, v205
  v_fmamk_f32 v206, v247, 0x41b00000, v250
  v_cos_f32 v206, v206
  v_fmamk_f32 v207, v247, 0x41b80000, v250
  v_cos_f32 v207, v207
  v_cvt_pk_bf16_f32 v64, v192, v193
  v_cvt_pk_bf16_f32 v65, v194, v195
  v_cvt_pk_bf16_f32 v66, v196, v197
  v_cvt_pk_bf16_f32 v67, v198, v199
  v_cvt_pk_bf16_f32 v68, v200, v201
  v_cvt_pk_bf16_f32 v69, v202, v203
  v_cvt_pk_bf16_f32 v70, v204, v205
  v_cvt_pk_bf16_f32 v71, v206, v207
  v_pk_fma_f32 v[192:193], v[200:201], v[248:249], v[192:193] op_sel_hi:[1,0,1] neg_lo:[0,0,1] neg_hi:[0,0,1]
  v_pk_fma_f32 v[194:195], v[202:203], v[248:249], v[194:195] op_sel_hi:[1,0,1] neg_lo:[0,0,1] neg_hi:[0,0,1]
  v_pk_fma_f32 v[196:197], v[204:205], v[248:249], v[196:197] op_sel_hi:[1,0,1] neg_lo:[0,0,1] neg_hi:[0,0,1]
  v_pk_fma_f32 v[198:199], v[206:207], v[248:249], v[198:199] op_sel_hi:[1,0,1] neg_lo:[0,0,1] neg_hi:[0,0,1]
  v_cvt_pk_bf16_f32 v72, v192, v193
  v_cvt_pk_bf16_f32 v73, v194, v195
  v_cvt_pk_bf16_f32 v74, v196, v197
  v_cvt_pk_bf16_f32 v75, v198, v199
  v_pk_fma_f32 v[200:201], v[192:193], v[248:249], v[200:201] op_sel_hi:[1,0,1] neg_lo:[0,0,1] neg_hi:[0,0,1]
  v_pk_fma_f32 v[202:203], v[194:195], v[248:249], v[202:203] op_sel_hi:[1,0,1] neg_lo:[0,0,1] neg_hi:[0,0,1]
  v_pk_fma_f32 v[204:205], v[196:197], v[248:249], v[204:205] op_sel_hi:[1,0,1] neg_lo:[0,0,1] neg_hi:[0,0,1]
  v_pk_fma_f32 v[206:207], v[198:199], v[248:249], v[206:207] op_sel_hi:[1,0,1] neg_lo:[0,0,1] neg_hi:[0,0,1]
  v_cvt_pk_bf16_f32 v76, v200, v201
  v_cvt_pk_bf16_f32 v77, v202, v203
  v_cvt_pk_bf16_f32 v78, v204, v205
  v_cvt_pk_bf16_f32 v79, v206, v207
  v_pk_fma_f32 v[192:193], v[200:201], v[248:249], v[192:193] op_sel_hi:[1,0,1] neg_lo:[0,0,1] neg_hi:[0,0,1]
  v_pk_fma_f32 v[194:195], v[202:203], v[248:249], v[194:195] op_sel_hi:[1,0,1] neg_lo:[0,0,1] neg_hi:[0,0,1]
  v_pk_fma_f32 v[196:197], v[204:205], v[248:249], v[196:197] op_sel_hi:[1,0,1] neg_lo:[0,0,1] neg_hi:[0,0,1]
  v_pk_fma_f32 v[198:199], v[206:207], v[248:249], v[198:199] op_sel_hi:[1,0,1] neg_lo:[0,0,1] neg_hi:[0,0,1]
  v_cvt_pk_bf16_f32 v80, v192, v193
  v_cvt_pk_bf16_f32 v81, v194, v195
  v_cvt_pk_bf16_f32 v82, v196, v197
  v_cvt_pk_bf16_f32 v83, v198, v199
  v_pk_fma_f32 v[200:201], v[192:193], v[248:249], v[200:201] op_sel_hi:[1,0,1] neg_lo:[0,0,1] neg_hi:[0,0,1]
  v_pk_fma_f32 v[202:203], v[194:195], v[248:249], v[202:203] op_sel_hi:[1,0,1] neg_lo:[0,0,1] neg_hi:[0,0,1]
  v_pk_fma_f32 v[204:205], v[196:197], v[248:249], v[204:205] op_sel_hi:[1,0,1] neg_lo:[0,0,1] neg_hi:[0,0,1]
  v_pk_fma_f32 v[206:207], v[198:199], v[248:249], v[206:207] op_sel_hi:[1,0,1] neg_lo:[0,0,1] neg_hi:[0,0,1]
  v_cvt_pk_bf16_f32 v84, v200, v201
  v_cvt_pk_bf16_f32 v85, v202, v203
  v_cvt_pk_bf16_f32 v86, v204, v205
  v_cvt_pk_bf16_f32 v87, v206, v207
  v_pk_fma_f32 v[192:193], v[200:201], v[248:249], v[192:193] op_sel_hi:[1,0,1] neg_lo:[0,0,1] neg_hi:[0,0,1]
  v_pk_fma_f32 v[194:195], v[202:203], v[248:249], v[194:195] op_sel_hi:[1,0,1] neg_lo:[0,0,1] neg_hi:[0,0,1]
  v_pk_fma_f32 v[196:197], v[204:205], v[248:249], v[196:197] op_sel_hi:[1,0,1] neg_lo:[0,0,1] neg_hi:[0,0,1]
  v_pk_fma_f32 v[198:199], v[206:207], v[248:249], v[198:199] op_sel_hi:[1,0,1] neg_lo:[0,0,1] neg_hi:[0,0,1]
  v_cvt_pk_bf16_f32 v88, v192, v193
  v_cvt_pk_bf16_f32 v89, v194, v195
  v_cvt_pk_bf16_f32 v90, v196, v197
  v_cvt_pk_bf16_f32 v91, v198, v199
  v_pk_fma_f32 v[200:201], v[192:193], v[248:249], v[200:201] op_sel_hi:[1,0,1] neg_lo:[0,0,1] neg_hi:[0,0,1]
  v_pk_fma_f32 v[202:203], v[194:195], v[248:249], v[202:203] op_sel_hi:[1,0,1] neg_lo:[0,0,1] neg_hi:[0,0,1]
  v_pk_fma_f32 v[204:205], v[196:197], v[248:249], v[204:205] op_sel_hi:[1,0,1] neg_lo:[0,0,1] neg_hi:[0,0,1]
  v_pk_fma_f32 v[206:207], v[198:199], v[248:249], v[206:207] op_sel_hi:[1,0,1] neg_lo:[0,0,1] neg_hi:[0,0,1]
  v_cvt_pk_bf16_f32 v92, v200, v201
  v_cvt_pk_bf16_f32 v93, v202, v203
  v_cvt_pk_bf16_f32 v94, v204, v205
  v_cvt_pk_bf16_f32 v95, v206, v207
  v_pk_fma_f32 v[192:193], v[200:201], v[248:249], v[192:193] op_sel_hi:[1,0,1] neg_lo:[0,0,1] neg_hi:[0,0,1]
  v_pk_fma_f32 v[194:195], v[202:203], v[248:249], v[194:195] op_sel_hi:[1,0,1] neg_lo:[0,0,1] neg_hi:[0,0,1]
  v_pk_fma_f32 v[196:197], v[204:205], v[248:249], v[196:197] op_sel_hi:[1,0,1] neg_lo:[0,0,1] neg_hi:[0,0,1]
  v_pk_fma_f32 v[198:199], v[206:207], v[248:249], v[198:199] op_sel_hi:[1,0,1] neg_lo:[0,0,1] neg_hi:[0,0,1]
  v_cvt_pk_bf16_f32 v96, v192, v193
  v_cvt_pk_bf16_f32 v97, v194, v195
  v_cvt_pk_bf16_f32 v98, v196, v197
  v_cvt_pk_bf16_f32 v99, v198, v199
  v_pk_fma_f32 v[200:201], v[192:193], v[248:249], v[200:201] op_sel_hi:[1,0,1] neg_lo:[0,0,1] neg_hi:[0,0,1]
  v_pk_fma_f32 v[202:203], v[194:195], v[248:249], v[202:203] op_sel_hi:[1,0,1] neg_lo:[0,0,1] neg_hi:[0,0,1]
  v_pk_fma_f32 v[204:205], v[196:197], v[248:249], v[204:205] op_sel_hi:[1,0,1] neg_lo:[0,0,1] neg_hi:[0,0,1]
  v_pk_fma_f32 v[206:207], v[198:199], v[248:249], v[206:207] op_sel_hi:[1,0,1] neg_lo:[0,0,1] neg_hi:[0,0,1]
  v_cvt_pk_bf16_f32 v100, v200, v201
  v_cvt_pk_bf16_f32 v101, v202, v203
  v_cvt_pk_bf16_f32 v102, v204, v205
  v_cvt_pk_bf16_f32 v103, v206, v207
  v_pk_fma_f32 v[192:193], v[200:201], v[248:249], v[192:193] op_sel_hi:[1,0,1] neg_lo:[0,0,1] neg_hi:[0,0,1]
  v_pk_fma_f32 v[194:195], v[202:203], v[248:249], v[194:195] op_sel_hi:[1,0,1] neg_lo:[0,0,1] neg_hi:[0,0,1]
  v_pk_fma_f32 v[196:197], v[204:205], v[248:249], v[196:197] op_sel_hi:[1,0,1] neg_lo:[0,0,1] neg_hi:[0,0,1]
  v_pk_fma_f32 v[198:199], v[206:207], v[248:249], v[198:199] op_sel_hi:[1,0,1] neg_lo:[0,0,1] neg_hi:[0,0,1]
  v_cvt_pk_bf16_f32 v104, v192, v193
  v_cvt_pk_bf16_f32 v105, v194, v195
  v_cvt_pk_bf16_f32 v106, v196, v197
  v_cvt_pk_bf16_f32 v107, v198, v199
  v_pk_fma_f32 v[200:201], v[192:193], v[248:249], v[200:201] op_sel_hi:[1,0,1] neg_lo:[0,0,1] neg_hi:[0,0,1]
  v_pk_fma_f32 v[202:203], v[194:195], v[248:249], v[202:203] op_sel_hi:[1,0,1] neg_lo:[0,0,1] neg_hi:[0,0,1]
  v_pk_fma_f32 v[204:205], v[196:197], v[248:249], v[204:205] op_sel_hi:[1,0,1] neg_lo:[0,0,1] neg_hi:[0,0,1]
  v_pk_fma_f32 v[206:207], v[198:199], v[248:249], v[206:207] op_sel_hi:[1,0,1] neg_lo:[0,0,1] neg_hi:[0,0,1]
  v_cvt_pk_bf16_f32 v108, v200, v201
  v_cvt_pk_bf16_f32 v109, v202, v203
  v_cvt_pk_bf16_f32 v110, v204, v205
  v_cvt_pk_bf16_f32 v111, v206, v207
  v_pk_fma_f32 v[192:193], v[200:201], v[248:249], v[192:193] op_sel_hi:[1,0,1] neg_lo:[0,0,1] neg_hi:[0,0,1]
  v_pk_fma_f32 v[194:195], v[202:203], v[248:249], v[194:195] op_sel_hi:[1,0,1] neg_lo:[0,0,1] neg_hi:[0,0,1]
  v_pk_fma_f32 v[196:197], v[204:205], v[248:249], v[196:197] op_sel_hi:[1,0,1] neg_lo:[0,0,1] neg_hi:[0,0,1]
  v_pk_fma_f32 v[198:199], v[206:207], v[248:249], v[198:199] op_sel_hi:[1,0,1] neg_lo:[0,0,1] neg_hi:[0,0,1]
  v_cvt_pk_bf16_f32 v112, v192, v193
  v_cvt_pk_bf16_f32 v113, v194, v195
  v_cvt_pk_bf16_f32 v114, v196, v197
  v_cvt_pk_bf16_f32 v115, v198, v199
  v_pk_fma_f32 v[200:201], v[192:193], v[248:249], v[200:201] op_sel_hi:[1,0,1] neg_lo:[0,0,1] neg_hi:[0,0,1]
  v_pk_fma_f32 v[202:203], v[194:195], v[248:249], v[202:203] op_sel_hi:[1,0,1] neg_lo:[0,0,1] neg_hi:[0,0,1]
  v_pk_fma_f32 v[204:205], v[196:197], v[248:249], v[204:205] op_sel_hi:[1,0,1] neg_lo:[0,0,1] neg_hi:[0,0,1]
  v_pk_fma_f32 v[206:207], v[198:199], v[248:249], v[206:207] op_sel_hi:[1,0,1] neg_lo:[0,0,1] neg_hi:[0,0,1]
  v_cvt_pk_bf16_f32 v116, v200, v201
  v_cvt_pk_bf16_f32 v117, v202, v203
  v_cvt_pk_bf16_f32 v118, v204, v205
  v_cvt_pk_bf16_f32 v119, v206, v207
  v_pk_fma_f32 v[192:193], v[200:201], v[248:249], v[192:193] op_sel_hi:[1,0,1] neg_lo:[0,0,1] neg_hi:[0,0,1]
  v_pk_fma_f32 v[194:195], v[202:203], v[248:249], v[194:195] op_sel_hi:[1,0,1] neg_lo:[0,0,1] neg_hi:[0,0,1]
  v_pk_fma_f32 v[196:197], v[204:205], v[248:249], v[196:197] op_sel_hi:[1,0,1] neg_lo:[0,0,1] neg_hi:[0,0,1]
  v_pk_fma_f32 v[198:199], v[206:207], v[248:249], v[198:199] op_sel_hi:[1,0,1] neg_lo:[0,0,1] neg_hi:[0,0,1]
  v_cvt_pk_bf16_f32 v120, v192, v193
  v_cvt_pk_bf16_f32 v121, v194, v195
  v_cvt_pk_bf16_f32 v122, v196, v197
  v_cvt_pk_bf16_f32 v123, v198, v199
  v_pk_fma_f32 v[200:201], v[192:193], v[248:249], v[200:201] op_sel_hi:[1,0,1] neg_lo:[0,0,1] neg_hi:[0,0,1]
  v_pk_fma_f32 v[202:203], v[194:195], v[248:249], v[202:203] op_sel_hi:[1,0,1] neg_lo:[0,0,1] neg_hi:[0,0,1]
  v_pk_fma_f32 v[204:205], v[196:197], v[248:249], v[204:205] op_sel_hi:[1,0,1] neg_lo:[0,0,1] neg_hi:[0,0,1]
  v_pk_fma_f32 v[206:207], v[198:199], v[248:249], v[206:207] op_sel_hi:[1,0,1] neg_lo:[0,0,1] neg_hi:[0,0,1]
  v_cvt_pk_bf16_f32 v124, v200, v201
  v_cvt_pk_bf16_f32 v125, v202, v203
  v_cvt_pk_bf16_f32 v126, v204, v205
  v_cvt_pk_bf16_f32 v127, v206, v207
  s_lshl_b32 s47, s39, 10
  s_add_u32 s47, s47, 65536
  v_lshl_add_u32 v253, v22, 5, s47
  v_lshl_add_u32 v24, v18, 3, v253
  v_lshl_add_u32 v252, s40, 4, v24
  s_lshl_b32 s47, s38, 7
  s_add_u32 s47, s47, 67584
  v_lshl_add_u32 v254, v22, 2, s47
  s_lshl_b32 s47, s40, 7
  s_add_u32 s47, s47, 67584
  v_lshl_add_u32 v255, v18, 4, s47
  v_and_b32 v25, 15, v0
  v_lshl_add_u32 v24, v25, 7, v23
  v_bfe_u32 v27, v0, 4, 1
  v_lshl_add_u32 v24, v27, 3, v24
  s_sub_u32 s47, s37, s59
  s_bfe_u32 s48, s47, 0x10002
  s_and_b32 s47, s47, 3
  s_lshl1_add_u32 s47, s47, s48
  s_lshl_b32 s47, s47, 13
  s_add_u32 s47, s47, s52
  v_add_u32 v236, s47, v24
  v_lshrrev_b32 v24, 1, v16
  v_lshl_add_u32 v24, s40, 2, v24
  v_xor_b32 v24, v24, v19
  v_lshl_add_u32 v24, v16, 3, v24
  s_lshr_b32 s48, s3, 2
  s_sub_u32 s47, s47, s48
  v_lshl_add_u32 v242, v24, 4, s47
  s_bfe_u32 s47, s2, 0x20001
  s_lshr_b32 s48, s2, 6
  s_lshl2_add_u32 s42, s47, s48
  s_and_b32 s47, s2, 1
  s_lshl3_add_u32 s41, s47, s37
  s_lshl3_add_u32 s43, s36, s37
  s_lshl2_add_u32 s60, s59, s38
  s_lshl_b32 s72, s59, 12
  s_add_u32 s61, s60, 4
  s_and_b32 s61, s61, 15
  s_add_u32 s73, s72, 0x1000
  s_and_b32 s73, s73, 0x3fff
  s_add_u32 s62, s61, 4
  s_and_b32 s62, s62, 15
  s_add_u32 s74, s73, 0x1000
  s_and_b32 s74, s74, 0x3fff
  s_add_u32 s63, s62, 4
  s_and_b32 s63, s63, 15
  s_add_u32 s75, s74, 0x1000
  s_and_b32 s75, s75, 0x3fff
  s_lshr_b32 s48, s37, 2
  s_add_u32 s48, s48, 1
  s_sub_u32 s49, 0, s48
  s_bitcmp1_b32 s37, 1
  s_cselect_b32 s48, s49, s48
  s_add_u32 s49, s54, s48
  s_and_b32 s55, s49, 31
  s_lshl_b32 s55, s55, 13
  s_lshl2_add_u32 s55, s37, s55
  s_add_u32 m0, s3, 16384
  s_add_u32 s76, s76, 2
  s_and_b32 s76, s76, 15
  s_lshl_b32 s53, s76, 15
  buffer_load_dwordx4 v2, s[12:15], s53 offen offset:0 lds
  s_ashr_i32 s50, s49, 6
  s_and_b32 s49, s49, 63
  s_lshl3_add_u32 s49, s49, s37
  s_lshl1_add_u32 s49, s49, s40
  s_lshl_b32 s49, s49, 11
  s_add_u32 s49, s49, 2097152
  v_add_u32 v24, s50, v22
  v_cmp_gt_u32 vcc, 32, v24
  buffer_load_dwordx4 v3, s[12:15], s53 offen offset:1024 lds
  v_and_b32 v24, 31, v24
  v_lshl_add_u32 v24, v18, 5, v24
  v_cndmask_b32 v238, 0, -1, vcc
  v_lshl_add_u32 v237, v24, 4, s49
  s_lshr_b32 s47, s3, 4
  s_add_u32 s47, s47, 68608
  v_lshl_add_u32 v239, v0, 2, s47
  s_movk_i32 s47, 3584
  buffer_load_dwordx4 v4, s[12:15], s53 offen offset:2048 lds
  v_mad_u32_u24 v24, v16, s47, v17
  v_lshl_add_u32 v224, s41, 7, v24
  v_add_u32 v225, 27648, v224
  v_add_u32 v226, 55296, v224
  v_add_u32 v227, 82944, v224
  s_movk_i32 s49, 10923
  s_mul_i32 s50, s41, 96
  s_movk_i32 s47, 218
  buffer_load_dwordx4 v5, s[12:15], s53 offen offset:3072 lds
  v_mul_u32_u24 v26, s49, v0
  v_lshrrev_b32 v26, 16, v26
  v_mad_u32_u24 v26, v26, s47, v0
  s_add_u32 s48, s50, 2048
  v_lshl_add_u32 v244, v26, 4, s48
  v_add_u32 v24, 64, v0
  v_mul_u32_u24 v26, s49, v24
  v_lshrrev_b32 v26, 16, v26
  s_add_u32 m0, s3, 32768
  s_add_u32 s76, s76, 2
  s_and_b32 s76, s76, 15
  s_lshl_b32 s53, s76, 15
  buffer_load_dwordx4 v2, s[12:15], s53 offen offset:0 lds
  v_mad_u32_u24 v26, v26, s47, v24
  s_add_u32 s48, s50, 1024
  v_lshl_add_u32 v245, v26, 4, s48
  v_add_u32 v24, 128, v0
  v_mul_u32_u24 v26, s49, v24
  v_lshrrev_b32 v26, 16, v26
  v_mad_u32_u24 v26, v26, s47, v24
  s_add_u32 s48, s50, 0
  buffer_load_dwordx4 v3, s[12:15], s53 offen offset:1024 lds
  v_lshl_add_u32 v246, v26, 4, s48
  s_mul_i32 s56, s38, 3072
  v_lshl_add_u32 v24, s38, 6, v0
  v_mov_b32 v26, 0x7f000000
  v_cmp_gt_u32 vcc, 8, v24
  v_lshlrev_b32 v24, 10, v24
  v_add_u32 v24, 1048576, v24
  v_lshl_add_u32 v240, s38, 4, v25
  buffer_load_dwordx4 v4, s[12:15], s53 offen offset:2048 lds
  v_cndmask_b32 v1, v26, v24, vcc
  v_cvt_f32_u32 v240, v240
  v_lshl_add_u32 v24, v18, 2, v27
  v_lshl_add_u32 v24, v24, 8, s36
  v_cvt_f32_u32 v24, v24
  v_mul_f32 v24, v24, v240
  v_mul_f32 v241, 0x3a000000, v24
  v_mul_f32 v240, 0x3d000000, v240
  buffer_load_dwordx4 v5, s[12:15], s53 offen offset:3072 lds
  v_xor_b32 v24, 32, v236
  v_xor_b32 v25, 64, v236
  v_xor_b32 v26, 96, v236
  s_waitcnt lgkmcnt(0)
  s_mov_b32 s45, 0x80008000
  s_mov_b32 s46, 0x40000
  s_mov_b32 s0, 0x8000
  s_movk_i32 s1, 8448
  s_waitcnt vmcnt(12)
  s_barrier
  ds_read_b128 v[128:131], v52 offset:0
  ds_read_b64_tr_b16 v[192:193], v48 offset:0
  ds_read_b64_tr_b16 v[194:195], v49 offset:0
  ds_read_b128 v[132:135], v53 offset:0
  ds_read_b64_tr_b16 v[196:197], v48 offset:2048
  ds_read_b64_tr_b16 v[198:199], v49 offset:2048
  ds_read_b128 v[136:139], v54 offset:0
  ds_read_b64_tr_b16 v[200:201], v48 offset:4096
  ds_read_b64_tr_b16 v[202:203], v49 offset:4096
  ds_read_b128 v[140:143], v55 offset:0
  ds_read_b64_tr_b16 v[204:205], v48 offset:6144
  ds_read_b64_tr_b16 v[206:207], v49 offset:6144
  s_add_u32 m0, s52, 32768
  s_add_u32 s77, s77, 128
  buffer_load_dwordx4 v20, s[8:11], s77 offen lds
  buffer_load_dwordx4 v21, s[8:11], s77 offen offset:1024 lds
  s_add_u32 m0, s52, 40960
  s_xor_b32 s53, s77, 512
  buffer_load_dwordx4 v20, s[8:11], s53 offen lds
  s_waitcnt lgkmcnt(0)
  v_dot2c_f32_bf16 v30, s44, v192
  v_dot2c_f32_bf16 v30, s44, v193
  v_dot2c_f32_bf16 v30, s44, v194
  v_dot2c_f32_bf16 v30, s44, v195
  v_dot2c_f32_bf16 v30, s44, v196
  v_dot2c_f32_bf16 v30, s44, v197
  v_dot2c_f32_bf16 v30, s44, v198
  v_dot2c_f32_bf16 v30, s44, v199
  v_dot2c_f32_bf16 v30, s44, v200
  v_dot2c_f32_bf16 v30, s44, v201
  ds_read_b128 a[0:3], v56 offset:0
  ds_read_b64_tr_b16 a[64:65], v50 offset:0
  ds_read_b64_tr_b16 a[66:67], v51 offset:0
  ds_read_b128 a[4:7], v57 offset:0
  ds_read_b64_tr_b16 a[68:69], v50 offset:2048
  ds_read_b64_tr_b16 a[70:71], v51 offset:2048
  v_dot2c_f32_bf16 v30, s44, v202
  v_dot2c_f32_bf16 v30, s44, v203
  v_dot2c_f32_bf16 v30, s44, v204
  v_dot2c_f32_bf16 v30, s44, v205
  v_dot2c_f32_bf16 v30, s44, v206
  v_dot2c_f32_bf16 v30, s44, v207
  v_dot2c_f32_bf16 v28, s44, v128
  v_dot2c_f32_bf16 v29, v128, v128
  v_dot2c_f32_bf16 v28, s44, v129
  v_dot2c_f32_bf16 v29, v129, v129
  buffer_load_dwordx4 v21, s[8:11], s53 offen offset:1024 lds
  s_add_u32 m0, s3, 49152
  s_add_u32 s76, s76, 2
  s_and_b32 s76, s76, 15
  s_lshl_b32 s53, s76, 15
  buffer_load_dwordx4 v2, s[12:15], s53 offen offset:0 lds
  v_dot2c_f32_bf16 v28, s44, v130
  v_dot2c_f32_bf16 v29, v130, v130
  v_dot2c_f32_bf16 v28, s44, v131
  v_dot2c_f32_bf16 v29, v131, v131
  v_dot2c_f32_bf16 v28, s44, v132
  v_dot2c_f32_bf16 v29, v132, v132
  v_dot2c_f32_bf16 v28, s44, v133
  v_dot2c_f32_bf16 v29, v133, v133
  v_dot2c_f32_bf16 v28, s44, v134
  v_dot2c_f32_bf16 v29, v134, v134
  ds_read_b128 a[8:11], v58 offset:0
  ds_read_b64_tr_b16 a[72:73], v50 offset:4096
  ds_read_b64_tr_b16 a[74:75], v51 offset:4096
  ds_read_b128 a[12:15], v59 offset:0
  ds_read_b64_tr_b16 a[76:77], v50 offset:6144
  ds_read_b64_tr_b16 a[78:79], v51 offset:6144
  v_dot2c_f32_bf16 v28, s44, v135
  v_dot2c_f32_bf16 v29, v135, v135
  v_dot2c_f32_bf16 v28, s44, v136
  v_dot2c_f32_bf16 v29, v136, v136
  v_dot2c_f32_bf16 v28, s44, v137
  v_dot2c_f32_bf16 v29, v137, v137
  v_dot2c_f32_bf16 v28, s44, v138
  v_dot2c_f32_bf16 v29, v138, v138
  v_dot2c_f32_bf16 v28, s44, v139
  v_dot2c_f32_bf16 v29, v139, v139
  buffer_load_dwordx4 v3, s[12:15], s53 offen offset:1024 lds
  buffer_load_dwordx4 v4, s[12:15], s53 offen offset:2048 lds
  v_dot2c_f32_bf16 v28, s44, v140
  v_dot2c_f32_bf16 v29, v140, v140
  v_dot2c_f32_bf16 v28, s44, v141
  v_dot2c_f32_bf16 v29, v141, v141
  v_dot2c_f32_bf16 v28, s44, v142
  v_dot2c_f32_bf16 v29, v142, v142
  v_dot2c_f32_bf16 v28, s44, v143
  v_dot2c_f32_bf16 v29, v143, v143
  s_waitcnt vmcnt(11) lgkmcnt(0)
  s_barrier
  v_mfma_f32_32x32x16_bf16 v[32:47], v[192:195], v[128:131], 0
  ds_read_b128 v[144:147], v52 offset:16384
  ds_read_b64_tr_b16 v[208:209], v48 offset:16384
  ds_read_b64_tr_b16 v[210:211], v49 offset:16384
  v_mfma_f32_32x32x16_bf16 v[32:47], v[196:199], v[132:135], v[32:47]
  ds_read_b128 v[148:151], v53 offset:16384
  ds_read_b64_tr_b16 v[212:213], v48 offset:18432
  ds_read_b64_tr_b16 v[214:215], v49 offset:18432
  buffer_load_dwordx4 v5, s[12:15], s53 offen offset:3072 lds
  v_mfma_f32_32x32x16_bf16 v[32:47], v[200:203], v[136:139], v[32:47]
  ds_read_b128 v[152:155], v54 offset:16384
  ds_read_b64_tr_b16 v[216:217], v48 offset:20480
  ds_read_b64_tr_b16 v[218:219], v49 offset:20480
  v_mfma_f32_32x32x16_bf16 v[32:47], v[204:207], v[140:143], v[32:47]
  ds_read_b128 v[156:159], v55 offset:16384
  ds_read_b64_tr_b16 v[220:221], v48 offset:22528
  ds_read_b64_tr_b16 v[222:223], v49 offset:22528
  s_add_u32 m0, s52, 49152
  s_add_u32 s77, s77, 128
  buffer_load_dwordx4 v20, s[8:11], s77 offen lds
  v_mfma_f32_32x32x16_bf16 v[32:47], a[64:67], a[0:3], v[32:47]
  ds_read_b128 a[16:19], v56 offset:16384
  ds_read_b64_tr_b16 a[80:81], v50 offset:16384
  ds_read_b64_tr_b16 a[82:83], v51 offset:16384
  buffer_load_dwordx4 v21, s[8:11], s77 offen offset:1024 lds
  v_mfma_f32_32x32x16_bf16 v[32:47], a[68:71], a[4:7], v[32:47]
  ds_read_b128 a[20:23], v57 offset:16384
  ds_read_b64_tr_b16 a[84:85], v50 offset:18432
  ds_read_b64_tr_b16 a[86:87], v51 offset:18432
  v_mfma_f32_32x32x16_bf16 v[32:47], a[72:75], a[8:11], v[32:47]
  ds_read_b128 a[24:27], v58 offset:16384
  ds_read_b64_tr_b16 a[88:89], v50 offset:20480
  ds_read_b64_tr_b16 a[90:91], v51 offset:20480
  s_add_u32 m0, s52, 57344
  s_xor_b32 s53, s77, 512
  buffer_load_dwordx4 v20, s[8:11], s53 offen lds
  v_mfma_f32_32x32x16_bf16 v[32:47], a[76:79], a[12:15], v[32:47]
  ds_read_b128 a[28:31], v59 offset:16384
  ds_read_b64_tr_b16 a[92:93], v50 offset:22528
  ds_read_b64_tr_b16 a[94:95], v51 offset:22528
  buffer_load_dwordx4 v21, s[8:11], s53 offen offset:1024 lds
  s_waitcnt lgkmcnt(12)
  v_dot2c_f32_bf16 v30, s44, v208
  v_dot2c_f32_bf16 v30, s44, v209
  v_dot2c_f32_bf16 v30, s44, v210
  v_dot2c_f32_bf16 v30, s44, v211
  v_dot2c_f32_bf16 v30, s44, v212
  v_dot2c_f32_bf16 v30, s44, v213
  v_dot2c_f32_bf16 v30, s44, v214
  v_dot2c_f32_bf16 v30, s44, v215
  v_dot2c_f32_bf16 v30, s44, v216
  v_dot2c_f32_bf16 v30, s44, v217
  v_dot2c_f32_bf16 v30, s44, v218
  v_dot2c_f32_bf16 v30, s44, v219
  v_dot2c_f32_bf16 v30, s44, v220
  v_dot2c_f32_bf16 v30, s44, v221
  v_dot2c_f32_bf16 v30, s44, v222
  v_dot2c_f32_bf16 v30, s44, v223
  v_dot2c_f32_bf16 v28, s44, v144
  v_dot2c_f32_bf16 v29, v144, v144
  v_dot2c_f32_bf16 v28, s44, v145
  v_dot2c_f32_bf16 v29, v145, v145
  v_dot2c_f32_bf16 v28, s44, v146
  s_add_u32 m0, s3, 0
  s_lshl_b32 s53, s60, 15
  buffer_load_dwordx4 v2, s[16:19], s53 offen offset:0 lds
  buffer_load_dwordx4 v3, s[16:19], s53 offen offset:1024 lds
  buffer_load_dwordx4 v4, s[16:19], s53 offen offset:2048 lds
  buffer_load_dwordx4 v5, s[16:19], s53 offen offset:3072 lds
  v_dot2c_f32_bf16 v29, v146, v146
  v_dot2c_f32_bf16 v28, s44, v147
  v_dot2c_f32_bf16 v29, v147, v147
  v_dot2c_f32_bf16 v28, s44, v148
  v_dot2c_f32_bf16 v29, v148, v148
  v_dot2c_f32_bf16 v28, s44, v149
  v_dot2c_f32_bf16 v29, v149, v149
  v_dot2c_f32_bf16 v28, s44, v150
  v_dot2c_f32_bf16 v29, v150, v150
  v_dot2c_f32_bf16 v28, s44, v151
  v_dot2c_f32_bf16 v29, v151, v151
  v_dot2c_f32_bf16 v28, s44, v152
  v_dot2c_f32_bf16 v29, v152, v152
  v_dot2c_f32_bf16 v28, s44, v153
  v_dot2c_f32_bf16 v29, v153, v153
  v_dot2c_f32_bf16 v28, s44, v154
  v_dot2c_f32_bf16 v29, v154, v154
  v_dot2c_f32_bf16 v28, s44, v155
  v_dot2c_f32_bf16 v29, v155, v155
  v_dot2c_f32_bf16 v28, s44, v156
  v_dot2c_f32_bf16 v29, v156, v156
  v_dot2c_f32_bf16 v28, s44, v157
  v_dot2c_f32_bf16 v29, v157, v157
  v_dot2c_f32_bf16 v28, s44, v158
  v_dot2c_f32_bf16 v29, v158, v158
  v_dot2c_f32_bf16 v28, s44, v159
  v_dot2c_f32_bf16 v29, v159, v159
  s_waitcnt vmcnt(12) lgkmcnt(0)
  s_barrier
  v_mfma_f32_32x32x16_bf16 v[32:47], v[208:211], v[144:147], v[32:47]
  ds_read_b128 v[160:163], v52 offset:32768
  ds_read_b64_tr_b16 v[192:193], v48 offset:32768
  ds_read_b64_tr_b16 v[194:195], v49 offset:32768
  v_mfma_f32_32x32x16_bf16 v[32:47], v[212:215], v[148:151], v[32:47]
  ds_read_b128 v[164:167], v53 offset:32768
  ds_read_b64_tr_b16 v[196:197], v48 offset:34816
  ds_read_b64_tr_b16 v[198:199], v49 offset:34816
  s_add_u32 m0, s3, 16384
  s_lshl_b32 s53, s61, 15
  buffer_load_dwordx4 v2, s[16:19], s53 offen offset:0 lds
  v_mfma_f32_32x32x16_bf16 v[32:47], v[216:219], v[152:155], v[32:47]
  ds_read_b128 v[168:171], v54 offset:32768
  ds_read_b64_tr_b16 v[200:201], v48 offset:36864
  ds_read_b64_tr_b16 v[202:203], v49 offset:36864
  v_mfma_f32_32x32x16_bf16 v[32:47], v[220:223], v[156:159], v[32:47]
  ds_read_b128 v[172:175], v55 offset:32768
  ds_read_b64_tr_b16 v[204:205], v48 offset:38912
  ds_read_b64_tr_b16 v[206:207], v49 offset:38912
  buffer_load_dwordx4 v3, s[16:19], s53 offen offset:1024 lds
  v_mfma_f32_32x32x16_bf16 v[32:47], a[80:83], a[16:19], v[32:47]
  ds_read_b128 a[32:35], v56 offset:32768
  ds_read_b64_tr_b16 a[64:65], v50 offset:32768
  ds_read_b64_tr_b16 a[66:67], v51 offset:32768
  v_mfma_f32_32x32x16_bf16 v[32:47], a[84:87], a[20:23], v[32:47]
  ds_read_b128 a[36:39], v57 offset:32768
  ds_read_b64_tr_b16 a[68:69], v50 offset:34816
  ds_read_b64_tr_b16 a[70:71], v51 offset:34816
  buffer_load_dwordx4 v4, s[16:19], s53 offen offset:2048 lds
  v_mfma_f32_32x32x16_bf16 v[32:47], a[88:91], a[24:27], v[32:47]
  ds_read_b128 a[40:43], v58 offset:32768
  ds_read_b64_tr_b16 a[72:73], v50 offset:36864
  ds_read_b64_tr_b16 a[74:75], v51 offset:36864
  v_mfma_f32_32x32x16_bf16 v[32:47], a[92:95], a[28:31], v[32:47]
  ds_read_b128 a[44:47], v59 offset:32768
  ds_read_b64_tr_b16 a[76:77], v50 offset:38912
  ds_read_b64_tr_b16 a[78:79], v51 offset:38912
  buffer_load_dwordx4 v5, s[16:19], s53 offen offset:3072 lds
  s_waitcnt lgkmcnt(12)
  v_dot2c_f32_bf16 v30, s44, v192
  v_dot2c_f32_bf16 v30, s44, v193
  v_dot2c_f32_bf16 v30, s44, v194
  v_dot2c_f32_bf16 v30, s44, v195
  v_dot2c_f32_bf16 v30, s44, v196
  v_dot2c_f32_bf16 v30, s44, v197
  v_dot2c_f32_bf16 v30, s44, v198
  v_dot2c_f32_bf16 v30, s44, v199
  v_dot2c_f32_bf16 v30, s44, v200
  v_dot2c_f32_bf16 v30, s44, v201
  v_dot2c_f32_bf16 v30, s44, v202
  v_dot2c_f32_bf16 v30, s44, v203
  v_dot2c_f32_bf16 v30, s44, v204
  v_dot2c_f32_bf16 v30, s44, v205
  v_dot2c_f32_bf16 v30, s44, v206
  v_dot2c_f32_bf16 v30, s44, v207
  v_dot2c_f32_bf16 v28, s44, v160
  v_dot2c_f32_bf16 v29, v160, v160
  v_dot2c_f32_bf16 v28, s44, v161
  v_dot2c_f32_bf16 v29, v161, v161
  v_dot2c_f32_bf16 v28, s44, v162
  v_dot2c_f32_bf16 v29, v162, v162
  v_dot2c_f32_bf16 v28, s44, v163
  v_dot2c_f32_bf16 v29, v163, v163
  v_dot2c_f32_bf16 v28, s44, v164
  v_dot2c_f32_bf16 v29, v164, v164
  v_dot2c_f32_bf16 v28, s44, v165
  v_dot2c_f32_bf16 v29, v165, v165
  v_dot2c_f32_bf16 v28, s44, v166
  v_dot2c_f32_bf16 v29, v166, v166
  v_dot2c_f32_bf16 v28, s44, v167
  v_dot2c_f32_bf16 v29, v167, v167
  v_dot2c_f32_bf16 v28, s44, v168
  v_dot2c_f32_bf16 v29, v168, v168
  v_dot2c_f32_bf16 v28, s44, v169
  v_dot2c_f32_bf16 v29, v169, v169
  v_dot2c_f32_bf16 v28, s44, v170
  v_dot2c_f32_bf16 v29, v170, v170
  v_dot2c_f32_bf16 v28, s44, v171
  v_dot2c_f32_bf16 v29, v171, v171
  v_dot2c_f32_bf16 v28, s44, v172
  v_dot2c_f32_bf16 v29, v172, v172
  v_dot2c_f32_bf16 v28, s44, v173
  v_dot2c_f32_bf16 v29, v173, v173
  v_dot2c_f32_bf16 v28, s44, v174
  v_dot2c_f32_bf16 v29, v174, v174
  v_dot2c_f32_bf16 v28, s44, v175
  v_dot2c_f32_bf16 v29, v175, v175
  s_waitcnt vmcnt(8) lgkmcnt(0)
  s_barrier
  v_mfma_f32_32x32x16_bf16 v[32:47], v[192:195], v[160:163], v[32:47]
  ds_read_b128 v[176:179], v52 offset:49152
  ds_read_b64_tr_b16 v[208:209], v48 offset:49152
  ds_read_b64_tr_b16 v[210:211], v49 offset:49152
  s_add_u32 m0, s3, 32768
  s_lshl_b32 s53, s62, 15
  buffer_load_dwordx4 v2, s[16:19], s53 offen offset:0 lds
  v_mfma_f32_32x32x16_bf16 v[32:47], v[196:199], v[164:167], v[32:47]
  ds_read_b128 v[180:183], v53 offset:49152
  ds_read_b64_tr_b16 v[212:213], v48 offset:51200
  ds_read_b64_tr_b16 v[214:215], v49 offset:51200
  buffer_load_dwordx4 v3, s[16:19], s53 offen offset:1024 lds
  v_mfma_f32_32x32x16_bf16 v[32:47], v[200:203], v[168:171], v[32:47]
  ds_read_b128 v[184:187], v54 offset:49152
  ds_read_b64_tr_b16 v[216:217], v48 offset:53248
  ds_read_b64_tr_b16 v[218:219], v49 offset:53248
  buffer_load_dwordx4 v4, s[16:19], s53 offen offset:2048 lds
  v_mfma_f32_32x32x16_bf16 v[32:47], v[204:207], v[172:175], v[32:47]
  ds_read_b128 v[188:191], v55 offset:49152
  ds_read_b64_tr_b16 v[220:221], v48 offset:55296
  ds_read_b64_tr_b16 v[222:223], v49 offset:55296
  buffer_load_dwordx4 v5, s[16:19], s53 offen offset:3072 lds
  v_mfma_f32_32x32x16_bf16 v[32:47], a[64:67], a[32:35], v[32:47]
  ds_read_b128 a[48:51], v56 offset:49152
  ds_read_b64_tr_b16 a[80:81], v50 offset:49152
  ds_read_b64_tr_b16 a[82:83], v51 offset:49152
  s_waitcnt lgkmcnt(3)
  v_dot2c_f32_bf16 v30, s44, v208
  v_dot2c_f32_bf16 v30, s44, v209
  v_dot2c_f32_bf16 v30, s44, v210
  v_dot2c_f32_bf16 v30, s44, v211
  v_dot2c_f32_bf16 v30, s44, v212
  v_dot2c_f32_bf16 v30, s44, v213
  v_dot2c_f32_bf16 v30, s44, v214
  v_dot2c_f32_bf16 v30, s44, v215
  v_dot2c_f32_bf16 v30, s44, v216
  v_dot2c_f32_bf16 v30, s44, v217
  v_dot2c_f32_bf16 v30, s44, v218
  v_dot2c_f32_bf16 v30, s44, v219
  ds_read_b128 a[52:55], v57 offset:49152
  ds_read_b64_tr_b16 a[84:85], v50 offset:51200
  ds_read_b64_tr_b16 a[86:87], v51 offset:51200
  ds_read_b128 a[56:59], v58 offset:49152
  ds_read_b64_tr_b16 a[88:89], v50 offset:53248
  v_dot2c_f32_bf16 v30, s44, v220
  v_dot2c_f32_bf16 v30, s44, v221
  v_dot2c_f32_bf16 v30, s44, v222
  v_dot2c_f32_bf16 v30, s44, v223
  v_dot2c_f32_bf16 v28, s44, v176
  v_dot2c_f32_bf16 v29, v176, v176
  v_dot2c_f32_bf16 v28, s44, v177
  v_dot2c_f32_bf16 v29, v177, v177
  v_mov_b32 v31, v30
  v_dot2c_f32_bf16 v28, s44, v178
  v_dot2c_f32_bf16 v29, v178, v178
  v_dot2c_f32_bf16 v28, s44, v179
  v_dot2c_f32_bf16 v29, v179, v179
  ds_read_b64_tr_b16 a[90:91], v51 offset:53248
  ds_read_b128 a[60:63], v59 offset:49152
  ds_read_b64_tr_b16 a[92:93], v50 offset:55296
  ds_read_b64_tr_b16 a[94:95], v51 offset:55296
  ds_read_b64 a[216:217], v236
  v_permlane32_swap_b32 v30, v31
  v_add_f32 v30, v30, v31
  v_dot2c_f32_bf16 v28, s44, v180
  v_dot2c_f32_bf16 v29, v180, v180
  v_dot2c_f32_bf16 v28, s44, v181
  v_dot2c_f32_bf16 v29, v181, v181
  v_dot2c_f32_bf16 v28, s44, v182
  v_dot2c_f32_bf16 v29, v182, v182
  v_dot2c_f32_bf16 v28, s44, v183
  v_dot2c_f32_bf16 v29, v183, v183
  v_dot2c_f32_bf16 v28, s44, v184
  v_dot2c_f32_bf16 v29, v184, v184
  v_dot2c_f32_bf16 v28, s44, v185
  v_dot2c_f32_bf16 v29, v185, v185
  ds_read_b64 a[218:219], v24
  ds_read_b64 a[220:221], v25
  ds_read_b64 a[222:223], v26
  ds_read_b128 a[224:227], v242 offset:0
  ds_read_b128 a[228:231], v242 offset:4096
  v_dot2c_f32_bf16 v28, s44, v186
  v_dot2c_f32_bf16 v29, v186, v186
  v_dot2c_f32_bf16 v28, s44, v187
  v_dot2c_f32_bf16 v29, v187, v187
  v_dot2c_f32_bf16 v28, s44, v188
  v_dot2c_f32_bf16 v29, v188, v188
  v_dot2c_f32_bf16 v28, s44, v189
  buffer_load_dword v7, v232, s[20:23], 0 offen
  buffer_load_dword v7, v232, s[24:27], 0 offen
  buffer_load_dword v6, v6, s[32:35], 0 offen sc1
  v_dot2c_f32_bf16 v29, v189, v189
  v_dot2c_f32_bf16 v28, s44, v190
  v_dot2c_f32_bf16 v29, v190, v190
  v_dot2c_f32_bf16 v28, s44, v191
  v_dot2c_f32_bf16 v29, v191, v191
  v_mfma_f32_32x32x16_bf16 v[32:47], a[68:71], a[36:39], v[32:47]
  ds_write_b32 v254, v30
  s_nop 0
  ds_write_b64 v252, v[28:29]
  v_mfma_f32_32x32x16_bf16 v[32:47], a[72:75], a[40:43], v[32:47]
  v_mfma_f32_32x32x16_bf16 v[32:47], a[76:79], a[44:47], v[32:47]
  s_waitcnt lgkmcnt(0)
  s_barrier
  ds_read_b128 v[16:19], v253
  ds_read_b128 v[20:23], v253 offset:16
  v_mfma_f32_32x32x16_bf16 v[32:47], v[208:211], v[176:179], v[32:47]
  ds_read_b128 v[48:51], v255 offset:0
  ds_read_b128 v[192:195], v255 offset:256
  ds_read_b128 v[52:55], v255 offset:32
  ds_read_b128 v[196:199], v255 offset:288
  ds_read_b128 v[56:59], v255 offset:64
  v_mfma_f32_32x32x16_bf16 v[32:47], v[212:215], v[180:183], v[32:47]
  ds_read_b128 v[200:203], v255 offset:320
  ds_read_b128 v[60:63], v255 offset:96
  ds_read_b128 v[204:207], v255 offset:352
  v_mfma_f32_32x32x16_bf16 v[32:47], v[216:219], v[184:187], v[32:47]
  v_mfma_f32_32x32x16_bf16 v[32:47], v[220:223], v[188:191], v[32:47]
  v_cmp_gt_u32 vcc, 32, v0
  s_waitcnt lgkmcnt(8)
  v_add_f32 v16, v16, v18
  v_add_f32 v20, v20, v22
  v_add_f32 v16, v16, v20
  v_mfma_f32_32x32x16_bf16 v[32:47], a[80:83], a[48:51], v[32:47]
  v_add_f32 v17, v17, v19
  v_add_f32 v21, v21, v23
  v_add_f32 v17, v17, v21
  v_mul_f32 v16, 0xbb000000, v16
  v_mul_f32 v17, 0x3b000000, v17
  v_mfma_f32_32x32x16_bf16 v[32:47], a[84:87], a[52:55], v[32:47]
  v_fma_f32 v17, -v16, v16, v17
  v_max_f32 v17, 0, v17
  v_add_f32 v18, 0x3727c5ac, v17
  v_fmamk_f32 v19, v18, 0x3727c5ac, v17
  v_mfma_f32_32x32x16_bf16 v[32:47], a[88:91], a[56:59], v[32:47]
  v_rsq_f32 v23, v19
  v_sqrt_f32 v17, v19
  v_mul_f32 v22, v23, v23
  v_mfma_f32_32x32x16_bf16 v[32:47], a[92:95], a[60:63], v[32:47]
  v_mul_f32 v23, 0xc0135761, v23
  v_mul_f32 v22, 0x3d372713, v22
  v_mul_f32_e64 v22, v22, v23
  s_waitcnt lgkmcnt(0)
  v_pk_add_f32 v[48:49], v[48:49], v[192:193]
  v_pk_add_f32 v[50:51], v[50:51], v[194:195]
  v_pk_add_f32 v[52:53], v[52:53], v[196:197]
  v_pk_add_f32 v[54:55], v[54:55], v[198:199]
  v_pk_add_f32 v[56:57], v[56:57], v[200:201]
  v_pk_add_f32 v[58:59], v[58:59], v[202:203]
  v_pk_add_f32 v[60:61], v[60:61], v[204:205]
  v_pk_add_f32 v[62:63], v[62:63], v[206:207]
  v_pk_fma_f32 v[32:33], v[48:49], v[16:17], v[32:33] op_sel_hi:[1,0,1]
  v_pk_fma_f32 v[34:35], v[50:51], v[16:17], v[34:35] op_sel_hi:[1,0,1]
  v_pk_fma_f32 v[40:41], v[56:57], v[16:17], v[40:41] op_sel_hi:[1,0,1]
  v_pk_fma_f32 v[42:43], v[58:59], v[16:17], v[42:43] op_sel_hi:[1,0,1]
  v_pk_mul_f32 v[48:49], v[32:33], v[32:33]
  v_pk_mul_f32 v[50:51], v[34:35], v[34:35]
  v_pk_mul_f32 v[56:57], v[40:41], v[40:41]
  v_pk_mul_f32 v[58:59], v[42:43], v[42:43]
  v_pk_fma_f32 v[48:49], v[48:49], v[22:23], v[22:23] op_sel:[0,0,1] op_sel_hi:[1,0,1]
  v_pk_fma_f32 v[50:51], v[50:51], v[22:23], v[22:23] op_sel:[0,0,1] op_sel_hi:[1,0,1]
  v_pk_fma_f32 v[56:57], v[56:57], v[22:23], v[22:23] op_sel:[0,0,1] op_sel_hi:[1,0,1]
  v_pk_fma_f32 v[58:59], v[58:59], v[22:23], v[22:23] op_sel:[0,0,1] op_sel_hi:[1,0,1]
  v_pk_mul_f32 v[48:49], v[48:49], v[32:33]
  v_exp_f32 v48, v48
  v_exp_f32 v49, v49
  v_pk_mul_f32 v[50:51], v[50:51], v[34:35]
  v_exp_f32 v50, v50
  v_exp_f32 v51, v51
  v_pk_mul_f32 v[56:57], v[56:57], v[40:41]
  v_exp_f32 v56, v56
  v_exp_f32 v57, v57
  v_pk_mul_f32 v[58:59], v[58:59], v[42:43]
  v_exp_f32 v58, v58
  v_exp_f32 v59, v59
  v_pk_fma_f32 v[48:49], v[48:49], v[16:17], v[16:17] op_sel:[0,1,1] op_sel_hi:[1,1,1]
  v_rcp_f32 v48, v48
  v_rcp_f32 v49, v49
  v_pk_fma_f32 v[50:51], v[50:51], v[16:17], v[16:17] op_sel:[0,1,1] op_sel_hi:[1,1,1]
  v_rcp_f32 v50, v50
  v_rcp_f32 v51, v51
  v_pk_fma_f32 v[56:57], v[56:57], v[16:17], v[16:17] op_sel:[0,1,1] op_sel_hi:[1,1,1]
  v_rcp_f32 v56, v56
  v_rcp_f32 v57, v57
  v_pk_fma_f32 v[58:59], v[58:59], v[16:17], v[16:17] op_sel:[0,1,1] op_sel_hi:[1,1,1]
  v_rcp_f32 v58, v58
  v_rcp_f32 v59, v59
  v_pk_mul_f32 v[48:49], v[48:49], v[32:33]
  v_pk_mul_f32 v[50:51], v[50:51], v[34:35]
  v_pk_mul_f32 v[56:57], v[56:57], v[40:41]
  v_pk_mul_f32 v[58:59], v[58:59], v[42:43]
  v_cvt_pk_bf16_f32 v8, v48, v49
  v_cvt_pk_bf16_f32 v9, v50, v51
  v_cvt_pk_bf16_f32 v10, v56, v57
  v_cvt_pk_bf16_f32 v11, v58, v59
  v_and_b32 v8, v238, v8
  v_and_b32 v9, v238, v9
  v_and_b32 v10, v238, v10
  v_and_b32 v11, v238, v11
  buffer_store_dwordx4 v[8:11], v237, s[32:35], 0 offen offset:0 sc1
  v_pk_fma_f32 v[36:37], v[52:53], v[16:17], v[36:37] op_sel_hi:[1,0,1]
  v_pk_fma_f32 v[38:39], v[54:55], v[16:17], v[38:39] op_sel_hi:[1,0,1]
  v_pk_fma_f32 v[44:45], v[60:61], v[16:17], v[44:45] op_sel_hi:[1,0,1]
  v_pk_fma_f32 v[46:47], v[62:63], v[16:17], v[46:47] op_sel_hi:[1,0,1]
  v_pk_mul_f32 v[52:53], v[36:37], v[36:37]
  v_pk_mul_f32 v[54:55], v[38:39], v[38:39]
  v_pk_mul_f32 v[60:61], v[44:45], v[44:45]
  v_pk_mul_f32 v[62:63], v[46:47], v[46:47]
  v_pk_fma_f32 v[52:53], v[52:53], v[22:23], v[22:23] op_sel:[0,0,1] op_sel_hi:[1,0,1]
  v_pk_fma_f32 v[54:55], v[54:55], v[22:23], v[22:23] op_sel:[0,0,1] op_sel_hi:[1,0,1]
  v_pk_fma_f32 v[60:61], v[60:61], v[22:23], v[22:23] op_sel:[0,0,1] op_sel_hi:[1,0,1]
  v_pk_fma_f32 v[62:63], v[62:63], v[22:23], v[22:23] op_sel:[0,0,1] op_sel_hi:[1,0,1]
  v_pk_mul_f32 v[52:53], v[52:53], v[36:37]
  v_exp_f32 v52, v52
  v_exp_f32 v53, v53
  v_pk_mul_f32 v[54:55], v[54:55], v[38:39]
  v_exp_f32 v54, v54
  v_exp_f32 v55, v55
  v_pk_mul_f32 v[60:61], v[60:61], v[44:45]
  v_exp_f32 v60, v60
  v_exp_f32 v61, v61
  v_pk_mul_f32 v[62:63], v[62:63], v[46:47]
  v_exp_f32 v62, v62
  v_exp_f32 v63, v63
  v_pk_fma_f32 v[52:53], v[52:53], v[16:17], v[16:17] op_sel:[0,1,1] op_sel_hi:[1,1,1]
  v_rcp_f32 v52, v52
  v_rcp_f32 v53, v53
  v_pk_fma_f32 v[54:55], v[54:55], v[16:17], v[16:17] op_sel:[0,1,1] op_sel_hi:[1,1,1]
  v_rcp_f32 v54, v54
  v_rcp_f32 v55, v55
  v_pk_fma_f32 v[60:61], v[60:61], v[16:17], v[16:17] op_sel:[0,1,1] op_sel_hi:[1,1,1]
  v_rcp_f32 v60, v60
  v_rcp_f32 v61, v61
  v_pk_fma_f32 v[62:63], v[62:63], v[16:17], v[16:17] op_sel:[0,1,1] op_sel_hi:[1,1,1]
  v_rcp_f32 v62, v62
  v_rcp_f32 v63, v63
  v_pk_mul_f32 v[52:53], v[52:53], v[36:37]
  v_pk_mul_f32 v[54:55], v[54:55], v[38:39]
  v_pk_mul_f32 v[60:61], v[60:61], v[44:45]
  v_pk_mul_f32 v[62:63], v[62:63], v[46:47]
  v_cvt_pk_bf16_f32 v12, v52, v53
  v_cvt_pk_bf16_f32 v13, v54, v55
  v_cvt_pk_bf16_f32 v14, v60, v61
  v_cvt_pk_bf16_f32 v15, v62, v63
  v_and_b32 v12, v238, v12
  v_and_b32 v13, v238, v13
  v_and_b32 v14, v238, v14
  v_and_b32 v15, v238, v15
  buffer_store_dwordx4 v[12:15], v237, s[32:35], 0 offen offset:1024 sc1
  v_mfma_f32_32x32x16_bf16 v[32:47], v[128:131], v[64:67], 0
  s_add_u32 m0, s3, 49152
  s_lshl_b32 s53, s63, 15
  buffer_load_dwordx4 v2, s[16:19], s53 offen offset:0 lds
  v_rsq_f32 v20, v18
  v_mfma_f32_32x32x16_bf16 v[48:63], a[0:3], v[64:67], 0
  s_nop 0
  v_mul_f32 v21, v16, v20
  v_cndmask_b32 v20, v21, v20, vcc
  v_fmamk_f32 v24, v240, 0x00000000, v241
  v_fmamk_f32 v25, v240, 0x3f800000, v241
  v_mfma_f32_32x32x16_bf16 v[32:47], v[132:135], v[68:71], v[32:47]
  buffer_load_dwordx4 v3, s[16:19], s53 offen offset:1024 lds
  ds_write_b32 v239, v20
  v_bfe_u32 v216, v0, 2, 4
  v_bfe_u32 v217, v0, 4, 1
  v_and_or_b32 v217, v216, 2, v217
  v_mfma_f32_32x32x16_bf16 v[48:63], a[4:7], v[68:71], v[48:63]
  v_lshlrev_b32 v217, 5, v217
  v_and_b32 v218, 3, v0
  v_lshl_add_u32 v217, v218, 3, v217
  v_lshl_add_u32 v228, v216, 7, v217
  v_xor_b32 v229, 32, v228
  v_mfma_f32_32x32x16_bf16 v[32:47], v[136:139], v[72:75], v[32:47]
  buffer_load_dwordx4 v4, s[16:19], s53 offen offset:2048 lds
  v_xor_b32 v230, 64, v228
  v_xor_b32 v231, 96, v228
  v_bfe_u32 v18, v0, 5, 1
  v_and_b32 v19, 15, v0
  v_mfma_f32_32x32x16_bf16 v[48:63], a[8:11], v[72:75], v[48:63]
  s_waitcnt vmcnt(12)
  s_barrier
  ds_read_b64_tr_b16 a[64:65], v228 offset:0
  ds_read_b64_tr_b16 a[66:67], v228 offset:2048
  v_mfma_f32_32x32x16_bf16 v[32:47], v[140:143], v[76:79], v[32:47]
  buffer_load_dwordx4 v5, s[16:19], s53 offen offset:3072 lds
  s_add_u32 m0, s3, 98304
  s_mul_i32 s53, s38, 114688
  ds_read_b64_tr_b16 a[68:69], v229 offset:0
  ds_read_b64_tr_b16 a[70:71], v229 offset:2048
  v_mfma_f32_32x32x16_bf16 v[48:63], a[12:15], v[76:79], v[48:63]
  ds_read_b64_tr_b16 a[72:73], v230 offset:0
  ds_read_b64_tr_b16 a[74:75], v230 offset:2048
  ds_read_b64_tr_b16 a[76:77], v231 offset:0
  s_lshr_b32 s47, s3, 4
  s_add_u32 s47, s47, 68608
  v_mfma_f32_32x32x16_bf16 v[32:47], v[144:147], v[80:83], v[32:47]
  buffer_load_dwordx4 v224, s[20:23], s53 offen offset:0 lds
  ds_read_b64_tr_b16 a[78:79], v231 offset:2048
  ds_read_b64_tr_b16 a[80:81], v228 offset:4096
  ds_read_b64_tr_b16 a[82:83], v228 offset:6144
  v_lshl_add_u32 v216, v18, 4, s47
  v_mfma_f32_32x32x16_bf16 v[48:63], a[16:19], v[80:83], v[48:63]
  ds_read_b64_tr_b16 a[84:85], v229 offset:4096
  ds_read_b64_tr_b16 a[86:87], v229 offset:6144
  ds_read_b64_tr_b16 a[88:89], v230 offset:4096
  v_lshl_add_u32 v217, s40, 4, v19
  v_mfma_f32_32x32x16_bf16 v[32:47], v[148:151], v[84:87], v[32:47]
  buffer_load_dwordx4 v225, s[20:23], s53 offen offset:1024 lds
  ds_read_b64_tr_b16 a[90:91], v230 offset:6144
  ds_read_b64_tr_b16 a[92:93], v231 offset:4096
  ds_read_b64_tr_b16 a[94:95], v231 offset:6144
  ds_read_b128 v[192:195], v216 offset:0
  v_mfma_f32_32x32x16_bf16 v[48:63], a[20:23], v[84:87], v[48:63]
  ds_read_b64_tr_b16 a[96:97], v228 offset:8192
  ds_read_b64_tr_b16 a[98:99], v228 offset:10240
  ds_read_b64_tr_b16 a[100:101], v229 offset:8192
  ds_read_b128 v[196:199], v216 offset:32
  ds_read_b128 v[200:203], v216 offset:64
  v_mfma_f32_32x32x16_bf16 v[32:47], v[152:155], v[88:91], v[32:47]
  buffer_load_dwordx4 v226, s[20:23], s53 offen offset:2048 lds
  ds_read_b64_tr_b16 a[102:103], v229 offset:10240
  ds_read_b64_tr_b16 a[104:105], v230 offset:8192
  ds_read_b64_tr_b16 a[106:107], v230 offset:10240
  ds_read_b128 v[204:207], v216 offset:96
  v_mfma_f32_32x32x16_bf16 v[48:63], a[24:27], v[88:91], v[48:63]
  ds_read_b64_tr_b16 a[108:109], v231 offset:8192
  ds_read_b64_tr_b16 a[110:111], v231 offset:10240
  ds_read_b64_tr_b16 a[112:113], v228 offset:12288
  v_lshl_add_u32 v217, v217, 2, s47
  v_mfma_f32_32x32x16_bf16 v[32:47], v[156:159], v[92:95], v[32:47]
  buffer_load_dwordx4 v227, s[20:23], s53 offen offset:3072 lds
  s_add_u32 m0, s3, 114688
  s_add_u32 s53, s38, 4
  s_mul_i32 s53, s53, 114688
  ds_read_b64_tr_b16 a[114:115], v228 offset:14336
  v_mfma_f32_32x32x16_bf16 v[48:63], a[28:31], v[92:95], v[48:63]
  ds_read_b64_tr_b16 a[116:117], v229 offset:12288
  ds_read_b64_tr_b16 a[118:119], v229 offset:14336
  ds_read_b64_tr_b16 a[120:121], v230 offset:12288
  ds_read2_b32 v[30:31], v217 offset0:0 offset1:32
  v_lshlrev_b32 v22, 31, v0
  v_mfma_f32_32x32x16_bf16 v[32:47], v[160:163], v[96:99], v[32:47]
  buffer_load_dwordx4 v224, s[20:23], s53 offen offset:0 lds
  ds_read_b64_tr_b16 a[122:123], v230 offset:14336
  ds_read_b64_tr_b16 a[124:125], v231 offset:12288
  ds_read_b64_tr_b16 a[126:127], v231 offset:14336
  v_or_b32 v22, 1.0, v22
  v_mfma_f32_32x32x16_bf16 v[48:63], a[32:35], v[96:99], v[48:63]
  ds_read_b64_tr_b16 a[128:129], v228 offset:16384
  ds_read_b64_tr_b16 a[130:131], v228 offset:18432
  ds_read_b64_tr_b16 a[132:133], v229 offset:16384
  v_lshrrev_b32 v21, 4, v0
  v_lshlrev_b32 v218, 9, v21
  v_mfma_f32_32x32x16_bf16 v[32:47], v[164:167], v[100:103], v[32:47]
  buffer_load_dwordx4 v225, s[20:23], s53 offen offset:1024 lds
  ds_read_b64_tr_b16 a[134:135], v229 offset:18432
  ds_read_b64_tr_b16 a[136:137], v230 offset:16384
  ds_read_b64_tr_b16 a[138:139], v230 offset:18432
  s_waitcnt vmcnt(12)
  v_readfirstlane_b32 s52, v6
  v_mfma_f32_32x32x16_bf16 v[48:63], a[36:39], v[100:103], v[48:63]
  ds_read_b64_tr_b16 a[140:141], v231 offset:16384
  ds_read_b64_tr_b16 a[142:143], v231 offset:18432
  ds_read_b64_tr_b16 a[144:145], v228 offset:20480
  s_add_u32 s6, s52, 0x9e3779b9
  s_mov_b32 s7, s6
  v_mov_b32 v6, s6
  v_mfma_f32_32x32x16_bf16 v[32:47], v[168:171], v[104:107], v[32:47]
  ds_read_b64_tr_b16 a[146:147], v228 offset:22528
  ds_read_b64_tr_b16 a[148:149], v229 offset:20480
  ds_read_b64_tr_b16 a[150:151], v229 offset:22528
  v_lshl_add_u32 v235, v19, 4, v218
  s_lshl_b32 s51, s54, 7
  v_mfma_f32_32x32x16_bf16 v[48:63], a[40:43], v[104:107], v[48:63]
  ds_read_b64_tr_b16 a[152:153], v230 offset:20480
  ds_read_b64_tr_b16 a[154:155], v230 offset:22528
  ds_read_b64_tr_b16 a[156:157], v231 offset:20480
  s_add_u32 s51, s51, s40
  s_lshl_b32 s51, s51, 8
  s_waitcnt vmcnt(10)
  s_barrier
  buffer_store_dword v6, v1, s[32:35], s55 offen sc1
  v_mfma_f32_32x32x16_bf16 v[32:47], v[172:175], v[108:111], v[32:47]
  buffer_load_dwordx4 v226, s[20:23], s53 offen offset:2048 lds
  ds_read_b64_tr_b16 a[158:159], v231 offset:22528
  ds_read_b64_tr_b16 a[160:161], v228 offset:24576
  ds_read_b64_tr_b16 a[162:163], v228 offset:26624
  s_add_u32 s49, s51, 2097152
  v_mfma_f32_32x32x16_bf16 v[48:63], a[44:47], v[108:111], v[48:63]
  ds_read_b64_tr_b16 a[164:165], v229 offset:24576
  ds_read_b64_tr_b16 a[166:167], v229 offset:26624
  ds_read_b64_tr_b16 a[168:169], v230 offset:24576
  v_add_u32 v16, s49, v235
  v_lshrrev_b32 v20, 3, v0
  v_mfma_f32_32x32x16_bf16 v[32:47], v[176:179], v[112:115], v[32:47]
  buffer_load_dwordx4 v227, s[20:23], s53 offen offset:3072 lds
  s_add_u32 m0, s3, 131072
  s_add_u32 s53, s38, 8
  s_mul_i32 s53, s53, 114688
  ds_read_b64_tr_b16 a[170:171], v230 offset:26624
  v_mfma_f32_32x32x16_bf16 v[48:63], a[48:51], v[112:115], v[48:63]
  ds_read_b64_tr_b16 a[172:173], v231 offset:24576
  ds_read_b64_tr_b16 a[174:175], v231 offset:26624
  ds_read_b64_tr_b16 a[176:177], v228 offset:28672
  s_lshl_b32 s49, s43, 10
  s_add_u32 s59, s49, 1048576
  v_mfma_f32_32x32x16_bf16 v[32:47], v[180:183], v[116:119], v[32:47]
  buffer_load_dwordx4 v224, s[20:23], s53 offen offset:0 lds
  ds_read_b64_tr_b16 a[178:179], v228 offset:30720
  ds_read_b64_tr_b16 a[180:181], v229 offset:28672
  ds_read_b64_tr_b16 a[182:183], v229 offset:30720
  s_lshl_b32 s64, s72, 1
  v_mfma_f32_32x32x16_bf16 v[48:63], a[52:55], v[116:119], v[48:63]
  ds_read_b64_tr_b16 a[184:185], v230 offset:28672
  ds_read_b64_tr_b16 a[186:187], v230 offset:30720
  ds_read_b64_tr_b16 a[188:189], v231 offset:28672
  s_add_u32 s65, s64, 0x1000
  s_lshl_b32 s66, s73, 1
  v_mfma_f32_32x32x16_bf16 v[32:47], v[184:187], v[120:123], v[32:47]
  buffer_load_dwordx4 v225, s[20:23], s53 offen offset:1024 lds
  ds_read_b64_tr_b16 a[190:191], v231 offset:30720
  s_add_u32 s67, s66, 0x1000
  s_lshl_b32 s68, s74, 1
  s_add_u32 s69, s68, 0x1000
  v_mfma_f32_32x32x16_bf16 v[48:63], a[56:59], v[120:123], v[48:63]
  s_lshl_b32 s70, s75, 1
  s_add_u32 s71, s70, 0x1000
  v_cos_f32 v26, v24
  v_mfma_f32_32x32x16_bf16 v[32:47], v[188:191], v[124:127], v[32:47]
  buffer_load_dwordx4 v226, s[20:23], s53 offen offset:2048 lds
  v_cos_f32 v27, v25
  v_sin_f32 v28, v24
  v_mfma_f32_32x32x16_bf16 v[48:63], a[60:63], v[124:127], v[48:63]
  v_sin_f32 v29, v25
  v_cvt_pk_bf16_f32 v26, v26, v27
  v_cvt_pk_bf16_f32 v28, v28, v29
  v_accvgpr_write_b32 a192, v26
  s_mov_b64 exec, 0
  s_cmp_eq_u32 s38, 0
  s_cbranch_scc1 L_pad3
  s_cmp_eq_u32 s38, 1
  s_cbranch_scc1 L_pad4
  s_cmp_eq_u32 s38, 2
  s_cbranch_scc1 L_pad5
  s_branch L_pad6
L_hopA:
  s_mov_b64 exec, -1
  buffer_load_dwordx4 v227, s[20:23], s53 offen offset:3072 lds
  s_add_u32 m0, s3, 147456
  s_add_u32 s53, s38, 12
  s_mul_i32 s53, s53, 114688
  buffer_load_dwordx4 v224, s[20:23], s53 offen offset:0 lds
  v_xor_b32 v27, s45, v28
  v_accvgpr_write_b32 a208, v28
  v_accvgpr_write_b32 a200, v27
  v_fmamk_f32 v24, v240, 0x40000000, v241
  v_fmamk_f32 v25, v240, 0x40400000, v241
  v_cos_f32 v26, v24
  v_cos_f32 v27, v25
  v_sin_f32 v28, v24
  v_sin_f32 v29, v25
  v_cvt_pk_bf16_f32 v26, v26, v27
  v_cvt_pk_bf16_f32 v28, v28, v29
  v_accvgpr_write_b32 a193, v26
  ds_read_b64_tr_b16 a[0:1], v228 offset:32768
  ds_read_b64_tr_b16 a[2:3], v228 offset:34816
  v_xor_b32 v27, s45, v28
  v_accvgpr_write_b32 a209, v28
  v_accvgpr_write_b32 a201, v27
  v_fmamk_f32 v24, v240, 0x41000000, v241
  v_fmamk_f32 v25, v240, 0x41100000, v241
  v_cos_f32 v26, v24
  v_cos_f32 v27, v25
  v_sin_f32 v28, v24
  v_sin_f32_e64 v29, v25
  v_cvt_pk_bf16_f32 v26, v26, v27
  v_cvt_pk_bf16_f32 v28, v28, v29
  v_accvgpr_write_b32 a194, v26
  buffer_load_dwordx4 v225, s[20:23], s53 offen offset:1024 lds
  buffer_load_dwordx4 v226, s[20:23], s53 offen offset:2048 lds
  v_xor_b32 v27, s45, v28
  v_accvgpr_write_b32 a210, v28
  v_accvgpr_write_b32 a202, v27
  v_fmamk_f32 v24, v240, 0x41200000, v241
  v_fmamk_f32 v25, v240, 0x41300000, v241
  v_cos_f32 v26, v24
  v_cos_f32 v27, v25
  v_sin_f32 v28, v24
  v_sin_f32_e64 v29, v25
  v_cvt_pk_bf16_f32 v26, v26, v27
  v_cvt_pk_bf16_f32 v28, v28, v29
  v_accvgpr_write_b32 a195, v26
  ds_read_b64_tr_b16 a[4:5], v229 offset:32768
  ds_read_b64_tr_b16 a[6:7], v229 offset:34816
  ds_read_b64_tr_b16 a[8:9], v230 offset:32768
  v_xor_b32 v27, s45, v28
  v_accvgpr_write_b32 a211, v28
  v_accvgpr_write_b32 a203, v27
  v_fmamk_f32 v24, v240, 0x3f000000, v241
  v_fmamk_f32 v25, v240, 0x3fc00000, v241
  v_cos_f32 v26, v24
  v_cos_f32 v27, v25
  v_sin_f32 v28, v24
  v_sin_f32_e64 v29, v25
  v_cvt_pk_bf16_f32 v26, v26, v27
  v_cvt_pk_bf16_f32 v28, v28, v29
  v_accvgpr_write_b32 a196, v26
  buffer_load_dwordx4 v227, s[20:23], s53 offen offset:3072 lds
  s_add_u32 m0, s56, 73728
  s_add_u32 s53, s38, 8
  s_mul_i32 s53, s53, 114688
  buffer_load_dwordx4 v244, s[20:23], s53 offen offset:0 lds
  v_xor_b32 v27, s45, v28
  v_accvgpr_write_b32 a212, v28
  v_accvgpr_write_b32 a204, v27
  v_fmamk_f32 v24, v240, 0x40200000, v241
  v_fmamk_f32 v25, v240, 0x40600000, v241
  v_cos_f32 v26, v24
  v_cos_f32 v27, v25
  v_sin_f32 v28, v24
  v_sin_f32 v29, v25
  v_cvt_pk_bf16_f32 v26, v26, v27
  v_cvt_pk_bf16_f32 v28, v28, v29
  v_accvgpr_write_b32 a197, v26
  ds_read_b64_tr_b16 a[10:11], v230 offset:34816
  ds_read_b64_tr_b16 a[12:13], v231 offset:32768
  ds_read_b64_tr_b16 a[14:15], v231 offset:34816
  v_xor_b32 v27, s45, v28
  v_accvgpr_write_b32 a213, v28
  v_accvgpr_write_b32 a205, v27
  v_fmamk_f32 v24, v240, 0x41080000, v241
  v_fmamk_f32 v25, v240, 0x41180000, v241
  v_cos_f32 v26, v24
  v_cos_f32 v27, v25
  v_sin_f32 v28, v24
  v_sin_f32_e64 v29, v25
  v_cvt_pk_bf16_f32 v26, v26, v27
  v_cvt_pk_bf16_f32 v28, v28, v29
  v_accvgpr_write_b32 a198, v26
  buffer_load_dwordx4 v245, s[20:23], s53 offen offset:1024 lds
  buffer_load_dwordx4 v246, s[20:23], s53 offen offset:2048 lds
  v_xor_b32 v27, s45, v28
  v_accvgpr_write_b32 a214, v28
  v_accvgpr_write_b32 a206, v27
  v_fmamk_f32 v24, v240, 0x41280000, v241
  v_fmamk_f32 v25, v240, 0x41380000, v241
  v_cos_f32 v26, v24
  v_cos_f32 v27, v25
  v_sin_f32 v28, v24
  v_sin_f32_e64 v29, v25
  v_cvt_pk_bf16_f32 v26, v26, v27
  v_cvt_pk_bf16_f32 v28, v28, v29
  v_accvgpr_write_b32 a199, v26
  ds_read_b64_tr_b16 a[16:17], v228 offset:36864
  ds_read_b64_tr_b16 a[18:19], v228 offset:38912
  v_xor_b32 v27, s45, v28
  v_accvgpr_write_b32 a215, v28
  v_accvgpr_write_b32 a207, v27
  s_waitcnt lgkmcnt(15)
  v_pk_fma_f32 v[32:33], v[48:49], v[22:23], v[32:33] op_sel_hi:[1,0,1]
  v_pk_fma_f32 v[34:35], v[50:51], v[22:23], v[34:35] op_sel_hi:[1,0,1]
  v_pk_fma_f32 v[36:37], v[52:53], v[22:23], v[36:37] op_sel_hi:[1,0,1]
  v_pk_fma_f32 v[38:39], v[54:55], v[22:23], v[38:39] op_sel_hi:[1,0,1]
  v_pk_fma_f32 v[40:41], v[56:57], v[22:23], v[40:41] op_sel_hi:[1,0,1]
  v_pk_fma_f32 v[42:43], v[58:59], v[22:23], v[42:43] op_sel_hi:[1,0,1]
  v_pk_fma_f32 v[44:45], v[60:61], v[22:23], v[44:45] op_sel_hi:[1,0,1]
  v_pk_fma_f32 v[46:47], v[62:63], v[22:23], v[46:47] op_sel_hi:[1,0,1]
  s_add_u32 m0, s56, 86016
  s_add_u32 s53, s38, 12
  s_nop 0
  s_mul_i32 s53, s53, 114688
  buffer_load_dwordx4 v244, s[20:23], s53 offen offset:0 lds
  buffer_load_dwordx4 v245, s[20:23], s53 offen offset:1024 lds
  s_load_dwordx8 s[8:15], s[32:33], s59 glc
  v_pk_mul_f32 v[32:33], v[32:33], v[192:193]
  v_pk_mul_f32 v[34:35], v[34:35], v[194:195]
  v_pk_mul_f32 v[36:37], v[36:37], v[196:197]
  v_pk_mul_f32 v[38:39], v[38:39], v[198:199]
  v_pk_mul_f32 v[40:41], v[40:41], v[200:201]
  v_pk_mul_f32 v[42:43], v[42:43], v[202:203]
  v_pk_mul_f32 v[44:45], v[44:45], v[204:205]
  v_pk_mul_f32 v[46:47], v[46:47], v[206:207]
  v_cvt_pk_bf16_f32 v208, v32, v33
  v_cvt_pk_bf16_f32 v209, v34, v35
  v_cvt_pk_bf16_f32 v210, v36, v37
  v_cvt_pk_bf16_f32 v211, v38, v39
  ds_read_b64_tr_b16 a[20:21], v229 offset:36864
  ds_read_b64_tr_b16 a[22:23], v229 offset:38912
  ds_read_b64_tr_b16 a[24:25], v230 offset:36864
  v_cvt_pk_bf16_f32 v212, v40, v41
  v_cvt_pk_bf16_f32 v213, v42, v43
  v_cvt_pk_bf16_f32 v214, v44, v45
  v_cvt_pk_bf16_f32 v215, v46, v47
  v_accvgpr_read_b32 v24, a216
  v_and_b32 v33, 0xffff0000, v24
  v_lshlrev_b32 v32, 16, v24
  v_accvgpr_read_b32 v24, a217
  v_and_b32 v35, 0xffff0000, v24
  v_lshlrev_b32 v34, 16, v24
  v_accvgpr_read_b32 v24, a218
  v_and_b32 v37, 0xffff0000, v24
  buffer_load_dwordx4 v246, s[20:23], s53 offen offset:2048 lds
  v_lshlrev_b32 v36, 16, v24
  v_accvgpr_read_b32 v24, a219
  v_and_b32 v39, 0xffff0000, v24
  v_lshlrev_b32 v38, 16, v24
  v_accvgpr_read_b32 v24, a220
  v_and_b32 v41, 0xffff0000, v24
  v_lshlrev_b32 v40, 16, v24
  v_accvgpr_read_b32 v24, a221
  v_and_b32 v43, 0xffff0000, v24
  v_lshlrev_b32 v42, 16, v24
  v_accvgpr_read_b32 v24, a222
  v_and_b32 v45, 0xffff0000, v24
  ds_read_b64_tr_b16 a[26:27], v230 offset:38912
  ds_read_b64_tr_b16 a[28:29], v231 offset:36864
  ds_read_b64_tr_b16 a[30:31], v231 offset:38912
  v_lshlrev_b32 v44, 16, v24
  v_accvgpr_read_b32 v24, a223
  v_and_b32 v47, 0xffff0000, v24
  v_lshlrev_b32 v46, 16, v24
  v_pk_fma_f32 v[32:33], v[32:33], v[30:31], v[30:31] op_sel:[0,0,1] op_sel_hi:[1,0,1]
  v_pk_fma_f32 v[34:35], v[34:35], v[30:31], v[30:31] op_sel:[0,0,1] op_sel_hi:[1,0,1]
  v_pk_fma_f32 v[36:37], v[36:37], v[30:31], v[30:31] op_sel:[0,0,1] op_sel_hi:[1,0,1]
  v_pk_fma_f32 v[38:39], v[38:39], v[30:31], v[30:31] op_sel:[0,0,1] op_sel_hi:[1,0,1]
  v_pk_fma_f32 v[40:41], v[40:41], v[30:31], v[30:31] op_sel:[0,0,1] op_sel_hi:[1,0,1]
  v_pk_fma_f32 v[42:43], v[42:43], v[30:31], v[30:31] op_sel:[0,0,1] op_sel_hi:[1,0,1]
  v_pk_fma_f32 v[44:45], v[44:45], v[30:31], v[30:31] op_sel:[0,0,1] op_sel_hi:[1,0,1]
  v_pk_fma_f32 v[46:47], v[46:47], v[30:31], v[30:31] op_sel:[0,0,1] op_sel_hi:[1,0,1]
L_sp1:
  s_waitcnt lgkmcnt(0)
  s_xor_b64 s[8:9], s[8:9], s[6:7]
  s_xor_b64 s[10:11], s[10:11], s[6:7]
  s_xor_b64 s[12:13], s[12:13], s[6:7]
  s_xor_b64 s[14:15], s[14:15], s[6:7]
  s_or_b64 s[8:9], s[8:9], s[12:13]
  s_or_b64 s[10:11], s[10:11], s[14:15]
  s_or_b64 s[8:9], s[8:9], s[10:11]
  s_cbranch_scc0 L_sp1_done
  s_sub_u32 s46, s46, 1
  s_cmp_lt_i32 s46, 0
  s_cbranch_scc1 L_sp1_done
  s_load_dwordx8 s[8:15], s[32:33], s59 glc
  s_branch L_sp1
L_sp1_done:
  s_nop 0
  buffer_load_dwordx4 v[128:131], v16, s[32:35], s64 offen offset:0 sc1
  ds_read_b64_tr_b16 a[32:33], v228 offset:40960
  ds_read_b64_tr_b16 a[34:35], v228 offset:43008
  ds_read_b64_tr_b16 a[36:37], v229 offset:40960
  ds_read_b64_tr_b16 a[38:39], v229 offset:43008
  ds_read_b64_tr_b16 a[40:41], v230 offset:40960
  buffer_load_dwordx4 v[132:135], v16, s[32:35], s64 offen offset:2048 sc1
  ds_read_b64_tr_b16 a[42:43], v230 offset:43008
  ds_read_b64_tr_b16 a[44:45], v231 offset:40960
  ds_read_b64_tr_b16 a[46:47], v231 offset:43008
  ds_read_b64_tr_b16 a[48:49], v228 offset:45056
  ds_read_b64_tr_b16 a[50:51], v228 offset:47104
  buffer_load_dwordx4 v[136:139], v16, s[32:35], s65 offen offset:0 sc1
  ds_read_b64_tr_b16 a[52:53], v229 offset:45056
  ds_read_b64_tr_b16 a[54:55], v229 offset:47104
  ds_read_b64_tr_b16 a[56:57], v230 offset:45056
  ds_read_b64_tr_b16 a[58:59], v230 offset:47104
  ds_read_b64_tr_b16 a[60:61], v231 offset:45056
  buffer_load_dwordx4 v[140:143], v16, s[32:35], s65 offen offset:2048 sc1
  ds_read_b64_tr_b16 a[62:63], v231 offset:47104
  s_waitcnt vmcnt(27)
  s_barrier
  ds_read_b64_tr_b16 v[64:65], v228 offset:49152
  ds_read_b64_tr_b16 v[66:67], v228 offset:51200
  ds_read_b64_tr_b16 v[68:69], v229 offset:49152
  ds_read_b64_tr_b16 v[70:71], v229 offset:51200
  buffer_load_dwordx4 v[144:147], v16, s[32:35], s66 offen offset:0 sc1
  ds_read_b64_tr_b16 v[72:73], v230 offset:49152
  ds_read_b64_tr_b16 v[74:75], v230 offset:51200
  ds_read_b64_tr_b16 v[76:77], v231 offset:49152
  ds_read_b64_tr_b16 v[78:79], v231 offset:51200
  ds_read_b64_tr_b16 v[80:81], v228 offset:53248
  buffer_load_dwordx4 v[148:151], v16, s[32:35], s66 offen offset:2048 sc1
  ds_read_b64_tr_b16 v[82:83], v228 offset:55296
  ds_read_b64_tr_b16 v[84:85], v229 offset:53248
  ds_read_b64_tr_b16 v[86:87], v229 offset:55296
  ds_read_b64_tr_b16 v[88:89], v230 offset:53248
  ds_read_b64_tr_b16 v[90:91], v230 offset:55296
  ds_read_b64_tr_b16 v[92:93], v231 offset:53248
  buffer_load_dwordx4 v[152:155], v16, s[32:35], s67 offen offset:0 sc1
  ds_read_b64_tr_b16 v[94:95], v231 offset:55296
  ds_read_b64_tr_b16 v[96:97], v228 offset:57344
  ds_read_b64_tr_b16 v[98:99], v228 offset:59392
  ds_read_b64_tr_b16 v[100:101], v229 offset:57344
  ds_read_b64_tr_b16 v[102:103], v229 offset:59392
  buffer_load_dwordx4 v[156:159], v16, s[32:35], s67 offen offset:2048 sc1
  ds_read_b64_tr_b16 v[104:105], v230 offset:57344
  ds_read_b64_tr_b16 v[106:107], v230 offset:59392
  ds_read_b64_tr_b16 v[108:109], v231 offset:57344
  ds_read_b64_tr_b16 v[110:111], v231 offset:59392
  ds_read_b64_tr_b16 v[112:113], v228 offset:61440
  buffer_load_dwordx4 v[160:163], v16, s[32:35], s68 offen offset:0 sc1
  ds_read_b64_tr_b16 v[114:115], v228 offset:63488
  ds_read_b64_tr_b16 v[116:117], v229 offset:61440
  ds_read_b64_tr_b16 v[118:119], v229 offset:63488
  ds_read_b64_tr_b16 v[120:121], v230 offset:61440
  ds_read_b64_tr_b16 v[122:123], v230 offset:63488
  buffer_load_dwordx4 v[164:167], v16, s[32:35], s68 offen offset:2048 sc1
  ds_read_b64_tr_b16 v[124:125], v231 offset:61440
  ds_read_b64_tr_b16 v[126:127], v231 offset:63488
  s_lshl_b32 s58, s56, 2
  v_and_b32 v24, 1, v0
  v_lshl_add_u32 v24, v24, 2, v18
  buffer_load_dwordx4 v[168:171], v16, s[32:35], s69 offen offset:0 sc1
  v_bfe_u32 v25, v0, 1, 1
  v_lshl_add_u32 v24, v24, 1, v25
  v_bfe_u32 v25, v0, 2, 3
  v_lshl_add_u32 v24, v24, 3, v25
  v_lshl_add_u32 v254, v24, 4, s58
  v_lshlrev_b32 v255, 4, v0
  s_waitcnt lgkmcnt(0)
  s_barrier
  s_waitcnt vmcnt(10)
  v_mfma_f32_16x16x32_bf16 v[32:35], a[64:67], v[128:131], v[32:35]
  buffer_load_dwordx4 v[172:175], v16, s[32:35], s69 offen offset:2048 sc1
  ds_write_b128 v254, v[208:211] offset:8192
  v_mfma_f32_16x16x32_bf16 v[36:39], a[68:71], v[128:131], v[36:39]
  ds_write_b128 v254, v[212:215] offset:8704
  s_lshl2_add_u32 s57, s3, 98304
  v_mfma_f32_16x16x32_bf16 v[40:43], a[72:75], v[128:131], v[40:43]
  s_lshl_b32 s49, s37, 12
  s_add_u32 s49, s49, s51
  v_mfma_f32_16x16x32_bf16 v[44:47], a[76:79], v[128:131], v[44:47]
  s_add_u32 s49, s49, 4194304
  s_waitcnt vmcnt(10)
  v_mfma_f32_16x16x32_bf16 v[32:35], a[80:83], v[132:135], v[32:35]
  buffer_load_dwordx4 v[176:179], v16, s[32:35], s70 offen offset:0 sc1
  v_add_u32 v252, s49, v235
  v_mfma_f32_16x16x32_bf16 v[36:39], a[84:87], v[132:135], v[36:39]
  s_lshl3_add_u32 s49, s54, s37
  s_lshl1_add_u32 s49, s49, s40
  v_mfma_f32_16x16x32_bf16 v[40:43], a[88:91], v[132:135], v[40:43]
  s_lshl_b32 s49, s49, 7
  s_add_u32 s49, s49, 262144
  v_mfma_f32_16x16x32_bf16 v[44:47], a[92:95], v[132:135], v[44:47]
  v_lshl_add_u32 v23, v18, 4, v19
  s_waitcnt vmcnt(10)
  v_mfma_f32_16x16x32_bf16 v[32:35], a[96:99], v[136:139], v[32:35]
  buffer_load_dwordx4 v[180:183], v16, s[32:35], s70 offen offset:2048 sc1
  v_lshl_add_u32 v25, v23, 2, s49
  v_mfma_f32_16x16x32_bf16 v[36:39], a[100:103], v[136:139], v[36:39]
  v_bfe_u32 v24, v0, 4, 1
  v_lshl_or_b32 v253, v24, 30, v25
  v_mfma_f32_16x16x32_bf16 v[40:43], a[104:107], v[136:139], v[40:43]
  v_mov_b32 v28, 0
  v_mov_b32 v29, 0
  v_mfma_f32_16x16x32_bf16 v[44:47], a[108:111], v[136:139], v[44:47]
  v_bfe_u32 v24, v0, 3, 1
  s_waitcnt vmcnt(10)
  v_mfma_f32_16x16x32_bf16 v[32:35], a[112:115], v[140:143], v[32:35]
  buffer_load_dwordx4 v[184:187], v16, s[32:35], s71 offen offset:0 sc1
  v_lshl_add_u32 v24, v21, 2, v24
  v_mfma_f32_16x16x32_bf16 v[36:39], a[116:119], v[140:143], v[36:39]
  v_and_b32 v25, 7, v0
  v_mul_u32_u24 v24, 4224, v24
  v_mfma_f32_16x16x32_bf16 v[40:43], a[120:123], v[140:143], v[40:43]
  v_lshl_add_u32 v24, v25, 4, v24
  s_lshl2_add_u32 s48, s37, s38
  v_mfma_f32_16x16x32_bf16 v[44:47], a[124:127], v[140:143], v[44:47]
  s_mul_i32 s48, s48, 67584
  s_waitcnt vmcnt(10)
  v_mfma_f32_16x16x32_bf16 v[32:35], a[128:131], v[144:147], v[32:35]
  buffer_load_dwordx4 v[188:191], v16, s[32:35], s71 offen offset:2048 sc1
  s_lshl_b32 s49, s36, 7
  v_mfma_f32_16x16x32_bf16 v[36:39], a[132:135], v[144:147], v[36:39]
  s_add_u32 s48, s48, s49
  s_add_u32 s48, s48, 6291456
  v_mfma_f32_16x16x32_bf16 v[40:43], a[136:139], v[144:147], v[40:43]
  v_add_u32 v236, s48, v24
  s_and_b32 s48, s2, 7
  v_mfma_f32_16x16x32_bf16 v[44:47], a[140:143], v[144:147], v[44:47]
  s_lshr_b32 s49, s2, 7
  s_waitcnt vmcnt(10)
  v_mfma_f32_16x16x32_bf16 v[32:35], a[144:147], v[148:151], v[32:35]
  s_add_u32 m0, s56, 49152
  s_mul_i32 s53, s38, 114688
  v_mfma_f32_16x16x32_bf16 v[36:39], a[148:151], v[148:151], v[36:39]
  buffer_load_dwordx4 v244, s[20:23], s53 offen offset:0 lds
  s_movk_i32 s64, 0
  v_mfma_f32_16x16x32_bf16 v[40:43], a[152:155], v[148:151], v[40:43]
  s_movk_i32 s65, 4096
  s_movk_i32 s66, 8192
  v_mfma_f32_16x16x32_bf16 v[44:47], a[156:159], v[148:151], v[44:47]
  s_movk_i32 s67, 12288
  s_waitcnt vmcnt(10)
  v_mfma_f32_16x16x32_bf16 v[32:35], a[160:163], v[152:155], v[32:35]
  s_movk_i32 s68, 16384
  s_movk_i32 s69, 20480
  v_mfma_f32_16x16x32_bf16 v[36:39], a[164:167], v[152:155], v[36:39]
  s_movk_i32 s70, 24576
  s_movk_i32 s71, 28672
  v_mfma_f32_16x16x32_bf16 v[40:43], a[168:171], v[152:155], v[40:43]
  s_movk_i32 s72, 0
  s_movk_i32 s76, 0
  v_mfma_f32_16x16x32_bf16 v[44:47], a[172:175], v[152:155], v[44:47]
  s_movk_i32 s73, 4096
  s_waitcnt vmcnt(9)
  v_mfma_f32_16x16x32_bf16 v[32:35], a[176:179], v[156:159], v[32:35]
  buffer_load_dwordx4 v245, s[20:23], s53 offen offset:1024 lds
  s_movk_i32 s77, 3072
  v_mfma_f32_16x16x32_bf16 v[36:39], a[180:183], v[156:159], v[36:39]
  s_movk_i32 s74, 8192
  s_movk_i32 s78, 6144
  v_mfma_f32_16x16x32_bf16 v[40:43], a[184:187], v[156:159], v[40:43]
  s_movk_i32 s75, 12288
  s_movk_i32 s79, 9216
  v_mfma_f32_16x16x32_bf16 v[44:47], a[188:191], v[156:159], v[44:47]
  s_lshl1_add_u32 s52, s48, s49
  s_waitcnt vmcnt(9)
  v_mfma_f32_16x16x32_bf16 v[32:35], a[0:3], v[160:163], v[32:35]
  s_lshl_b32 s48, s52, 7
  s_bfe_u32 s49, s2, 0x10006
  v_mfma_f32_16x16x32_bf16 v[36:39], a[4:7], v[160:163], v[36:39]
  s_add_u32 s48, s48, s49
  s_lshl_b32 s48, s48, 7
  v_mfma_f32_16x16x32_bf16 v[40:43], a[8:11], v[160:163], v[40:43]
  s_lshl2_add_u32 s55, s37, s48
  s_add_u32 s55, s55, 128
  v_mfma_f32_16x16x32_bf16 v[44:47], a[12:15], v[160:163], v[44:47]
  buffer_load_dwordx4 v246, s[20:23], s53 offen offset:2048 lds
  s_waitcnt vmcnt(9)
  v_mfma_f32_16x16x32_bf16 v[32:35], a[16:19], v[164:167], v[32:35]
  s_add_u32 m0, s56, 61440
  s_add_u32 s53, s38, 4
  v_mfma_f32_16x16x32_bf16 v[36:39], a[20:23], v[164:167], v[36:39]
  s_mul_i32 s53, s53, 114688
  v_lshl_add_u32 v24, s38, 6, v0
  v_mfma_f32_16x16x32_bf16 v[40:43], a[24:27], v[164:167], v[40:43]
  v_mov_b32 v26, 0x7f000000
  v_cmp_gt_u32 vcc, 16, v24
  v_mfma_f32_16x16x32_bf16 v[44:47], a[28:31], v[164:167], v[44:47]
  v_lshlrev_b32 v25, 10, v24
  s_waitcnt vmcnt(8)
  v_mfma_f32_16x16x32_bf16 v[32:35], a[32:35], v[168:171], v[32:35]
  v_add_u32 v25, 1048576, v25
  v_cndmask_b32 v1, v26, v25, vcc
  v_mfma_f32_16x16x32_bf16 v[36:39], a[36:39], v[168:171], v[36:39]
  v_cmp_eq_u32 vcc, 0, v24
  s_nop 0
  v_mfma_f32_16x16x32_bf16 v[40:43], a[40:43], v[168:171], v[40:43]
  buffer_load_dwordx4 v244, s[20:23], s53 offen offset:0 lds
  v_cndmask_b32 v237, v26, v25, vcc
  v_mfma_f32_16x16x32_bf16 v[44:47], a[44:47], v[168:171], v[44:47]
  s_mul_i32 s48, s38, 196608
  s_waitcnt vmcnt(8)
  v_mfma_f32_16x16x32_bf16 v[32:35], a[48:51], v[172:175], v[32:35]
  s_add_u32 s48, s48, 1048576
  v_add_u32 v248, s48, v2
  v_mfma_f32_16x16x32_bf16 v[36:39], a[52:55], v[172:175], v[36:39]
  v_lshl_add_u32 v2, s38, 18, v2
  v_add_u32 v249, s48, v3
  v_mfma_f32_16x16x32_bf16 v[40:43], a[56:59], v[172:175], v[40:43]
  v_lshl_add_u32 v3, s38, 18, v3
  v_add_u32 v250, s48, v4
  v_mfma_f32_16x16x32_bf16 v[44:47], a[60:63], v[172:175], v[44:47]
  v_lshl_add_u32 v4, s38, 18, v4
  s_waitcnt vmcnt(7)
  v_mfma_f32_16x16x32_bf16 v[32:35], v[64:67], v[176:179], v[32:35]
  v_add_u32 v251, s48, v5
  v_lshl_add_u32 v5, s38, 18, v5
  v_mfma_f32_16x16x32_bf16 v[36:39], v[68:71], v[176:179], v[36:39]
  buffer_load_dwordx4 v245, s[20:23], s53 offen offset:1024 lds
  s_waitcnt lgkmcnt(0)
  v_mfma_f32_16x16x32_bf16 v[40:43], v[72:75], v[176:179], v[40:43]
  s_barrier
  v_mfma_f32_16x16x32_bf16 v[44:47], v[76:79], v[176:179], v[44:47]
  ds_read_b128 v[48:51], v255 offset:8192
  s_waitcnt vmcnt(7)
  v_mfma_f32_16x16x32_bf16 v[32:35], v[80:83], v[180:183], v[32:35]
  ds_read_b128 v[52:55], v255 offset:9216
  ds_read_b128 v[56:59], v255 offset:32768
  v_mfma_f32_16x16x32_bf16 v[36:39], v[84:87], v[180:183], v[36:39]
  ds_read_b128 v[60:63], v255 offset:33792
  ds_read_b128 v[192:195], v255 offset:20480
  v_mfma_f32_16x16x32_bf16 v[40:43], v[88:91], v[180:183], v[40:43]
  ds_read_b128 v[196:199], v255 offset:21504
  ds_read_b128 v[200:203], v255 offset:45056
  v_mfma_f32_16x16x32_bf16 v[44:47], v[92:95], v[180:183], v[44:47]
  ds_read_b128 v[204:207], v255 offset:46080
  s_waitcnt vmcnt(6)
  v_mfma_f32_16x16x32_bf16 v[32:35], v[96:99], v[184:187], v[32:35]
  buffer_load_dwordx4 v246, s[20:23], s53 offen offset:2048 lds
  v_add_u32 v228, 98304, v228
  v_mfma_f32_16x16x32_bf16 v[36:39], v[100:103], v[184:187], v[36:39]
  v_add_u32 v229, 98304, v229
  v_add_u32 v230, 98304, v230
  v_mfma_f32_16x16x32_bf16 v[40:43], v[104:107], v[184:187], v[40:43]
  v_add_u32 v231, 98304, v231
  s_lshl_b32 s48, s38, 5
  v_mfma_f32_16x16x32_bf16 v[44:47], v[108:111], v[184:187], v[44:47]
  v_xor_b32 v233, s48, v228
  s_waitcnt vmcnt(6)
  v_mfma_f32_16x16x32_bf16 v[32:35], v[112:115], v[188:191], v[32:35]
  v_bfe_u32 v24, v0, 2, 4
  v_mul_u32_u24 v24, 96, v24
  v_mfma_f32_16x16x32_bf16 v[36:39], v[116:119], v[188:191], v[36:39]
  v_and_b32 v25, 3, v0
  v_lshl_add_u32 v24, v25, 3, v24
  v_mfma_f32_16x16x32_bf16 v[40:43], v[120:123], v[188:191], v[40:43]
  v_add_u32 v232, 49152, v24
  s_min_u32 s48, s48, 64
  v_mfma_f32_16x16x32_bf16 v[44:47], v[124:127], v[188:191], v[44:47]
  v_add_u32_e64 v220, s48, v232
  v_cvt_pk_bf16_f32 v8, v32, v33
  v_cvt_pk_bf16_f32 v9, v34, v35
  v_cvt_pk_bf16_f32 v10, v36, v37
  v_cvt_pk_bf16_f32 v11, v38, v39
  buffer_store_dwordx4 v[8:11], v252, s[32:35], 0 offen offset:0 sc1
L_pad3:
  s_cbranch_execz L_hopA
  v_cvt_pk_bf16_f32 v12, v40, v41
  v_cvt_pk_bf16_f32 v13, v42, v43
  v_cvt_pk_bf16_f32 v14, v44, v45
  v_cvt_pk_bf16_f32 v15, v46, v47
  buffer_store_dwordx4 v[12:15], v252, s[32:35], 0 offen offset:2048 sc1
  v_dot2c_f32_bf16 v28, s44, v8
  v_dot2c_f32_bf16 v29, v8, v8
  v_dot2c_f32_bf16 v28, s44, v9
  v_dot2c_f32_bf16 v29, v9, v9
  v_dot2c_f32_bf16 v28, s44, v10
  v_dot2c_f32_bf16 v29, v10, v10
  v_dot2c_f32_bf16 v28, s44, v11
  v_dot2c_f32_bf16 v29, v11, v11
  v_dot2c_f32_bf16 v28, s44, v12
  v_dot2c_f32_bf16 v29, v12, v12
  v_dot2c_f32_bf16 v28, s44, v13
  v_dot2c_f32_bf16 v29, v13, v13
  v_dot2c_f32_bf16 v28, s44, v14
  v_dot2c_f32_bf16 v29, v14, v14
  v_dot2c_f32_bf16 v28, s44, v15
  v_dot2c_f32_bf16 v29, v15, v15
  v_mov_b32 v124, s44
  v_mov_b32 v125, s44
  v_mov_b32 v126, s44
  v_permlane32_swap_b32 v28, v29
  v_add_f32 v28, v28, v29
  v_mov_b32 v29, v28
  v_mov_b32 v127, s44
  v_and_b32 v19, 48, v0
  v_permlane16_swap_b32 v28, v29
  v_add_f32 v28, v28, v29
  buffer_store_dword v28, v253, s[32:35], 0 offen sc1
  s_lshl1_add_u32 s50, s42, s39
  s_lshr_b32 s49, s50, 2
  s_and_b32 s50, s50, 3
  s_lshl_b32 s47, s49, 1
  s_add_u32 s48, s47, s50
  s_sub_u32 s47, s50, s47
  s_add_u32 s47, s47, 29
  s_cmp_lt_u32 s50, 2
  s_cselect_b32 s48, s48, s47
  s_cmp_eq_u32 s48, 32
  s_cselect_b32 s48, 16, s48
  s_waitcnt lgkmcnt(0)
  v_mfma_f32_16x16x32_bf16 v[64:67], a[192:195], v[48:51], 0
  s_lshl_b32 s49, s40, 5
  s_add_u32 s51, s48, s49
  v_mfma_f32_16x16x32_bf16 v[68:71], a[200:203], v[48:51], 0
  s_lshl_b32 s49, s51, 15
  s_add_u32 s49, s49, 4194304
  v_mfma_f32_16x16x32_bf16 v[72:75], a[192:195], v[52:55], 0
  v_add_u32 v30, s49, v235
  s_lshl_b32 s49, s51, 11
  v_mfma_f32_16x16x32_bf16 v[76:79], a[200:203], v[52:55], 0
  s_add_u32 s49, s49, 262144
  v_bfe_u32 v24, v0, 4, 1
  v_mfma_f32_16x16x32_bf16 v[64:67], a[196:199], v[56:59], v[64:67]
  v_lshl_add_u32 v24, v24, 5, v23
  v_lshl_add_u32 v31, v24, 2, s49
  v_mfma_f32_16x16x32_bf16 v[68:71], a[204:207], v[56:59], v[68:71]
  s_lshl4_add_u32 s49, s42, s41
  s_lshl3_add_u32 s49, s49, s39
  v_mfma_f32_16x16x32_bf16 v[72:75], a[196:199], v[60:63], v[72:75]
  s_lshl_b32 s49, s49, 7
  s_add_u32 s59, s49, 1048704
  v_mfma_f32_16x16x32_bf16 v[76:79], a[204:207], v[60:63], v[76:79]
  v_lshl_add_u32 v18, s38, 6, v19
  s_sub_u32 s49, s58, 98304
  v_mfma_f32_16x16x32_bf16 v[64:67], a[208:211], v[192:195], v[64:67]
  v_add_u32 v240, s49, v228
  v_lshl_add_u32 v244, s38, 14, v228
  v_mfma_f32_16x16x32_bf16 v[68:71], a[192:195], v[192:195], v[68:71]
  v_add_u32 v241, s49, v229
  v_lshl_add_u32 v245, s38, 14, v229
  v_mfma_f32_16x16x32_bf16 v[72:75], a[208:211], v[196:199], v[72:75]
  v_add_u32 v242, s49, v230
  v_lshl_add_u32 v246, s38, 14, v230
  v_mfma_f32_16x16x32_bf16 v[76:79], a[192:195], v[196:199], v[76:79]
  v_add_u32 v243, s49, v231
  v_lshl_add_u32 v247, s38, 14, v231
  v_mfma_f32_16x16x32_bf16 v[64:67], a[212:215], v[200:203], v[64:67]
  v_mfma_f32_16x16x32_bf16 v[68:71], a[196:199], v[200:203], v[68:71]
  v_mfma_f32_16x16x32_bf16 v[72:75], a[212:215], v[204:207], v[72:75]
  v_mfma_f32_16x16x32_bf16 v[76:79], a[196:199], v[204:207], v[76:79]
  s_nop 5
  v_cvt_pk_bf16_f32 v80, v64, v68
  s_nop 0
  v_cvt_pk_bf16_f32 v81, v72, v76
  v_cvt_pk_bf16_f32 v82, v65, v69
  v_cvt_pk_bf16_f32 v83, v73, v77
  v_cvt_pk_bf16_f32 v84, v66, v70
  v_cvt_pk_bf16_f32 v85, v74, v78
  v_cvt_pk_bf16_f32 v86, v67, v71
  v_cvt_pk_bf16_f32 v87, v75, v79
  v_mov_b32 v64, v80
  v_mov_b32 v65, v81
  v_mov_b32 v66, v84
  v_mov_b32_e64 v67, v85
  v_mov_b32_dpp v80, v82 row_ror:8 row_mask:0xf bank_mask:0xc
  v_mov_b32_dpp v81, v83 row_ror:8 row_mask:0xf bank_mask:0xc
  v_mov_b32_dpp v84, v86 row_ror:8 row_mask:0xf bank_mask:0xc
  v_mov_b32_dpp v85, v87 row_ror:8 row_mask:0xf bank_mask:0xc
  v_mov_b32_dpp v82, v64 row_ror:8 row_mask:0xf bank_mask:0x3
  v_mov_b32_dpp v83, v65 row_ror:8 row_mask:0xf bank_mask:0x3
  v_mov_b32_dpp v86, v66 row_ror:8 row_mask:0xf bank_mask:0x3
  v_mov_b32_dpp v87, v67 row_ror:8 row_mask:0xf bank_mask:0x3
  s_mul_i32 s49, s51, 114688
  s_add_u32 s49, s49, 9437184
  v_lshl_add_u32 v24, v0, 4, s49
  v_lshl_add_u32 v238, s41, 12, v24
  s_mul_i32 s49, s41, 3072
  s_add_u32 s49, s49, 65536
  v_add_u32 v239, s49, v24
  s_bfe_u32 s49, s2, 0x40003
  s_lshl4_add_u32 s49, s52, s49
  s_lshl3_add_u32 s49, s49, s38
  s_lshl_b32 s49, s49, 7
  s_add_u32 s52, s49, 1049088
  v_and_b32 v21, 7, v0
  v_lshlrev_b32 v24, 16, v20
  v_lshl_add_u32 v24, v21, 4, v24
  s_add_u32 s49, s3, s43
  v_lshl_add_u32 v221, s49, 7, v24
  s_mul_i32 s49, s36, 114688
  s_add_u32 s49, s49, 9437184
  v_lshl_add_u32 v24, v0, 4, s49
  v_lshl_add_u32 v252, s38, 14, v24
  v_add_u32 v253, 3670016, v252
  s_add_u32 s49, s58, 65536
  v_add_u32 v254, s49, v24
  v_add_u32 v255, 3670016, v254
  v_accvgpr_read_b32 v116, a224
  v_accvgpr_read_b32 v117, a225
  v_accvgpr_read_b32 v118, a226
  v_accvgpr_read_b32 v119, a227
  v_accvgpr_read_b32 v120, a228
  v_accvgpr_read_b32 v121, a229
  v_accvgpr_read_b32 v122, a230
  v_accvgpr_read_b32 v123, a231
  s_lshl1_add_u32 s48, s37, s40
  s_sub_u32 s47, 15, s48
  s_sub_u32 s50, 64, s54
  s_and_b32 s50, s50, 63
  s_cselect_b32 s49, 31, 32
  s_cmp_lt_u32 s37, 4
  s_cselect_b32 s50, s54, s50
  s_cselect_b32 s47, s48, s47
  s_cselect_b64 vcc, -1, 0
  v_and_b32 v22, 31, v0
  v_bfe_u32 v23, v0, 5, 1
  s_and_b32 s47, s47, 6
  v_min_u32 v24, 2, v20
  v_add_u32 v24, s47, v24
  v_and_b32 v24, 7, v24
  v_lshl_add_u32 v24, v24, 2, s38
  v_lshl_add_u32 v24, v24, 3, v21
  v_lshlrev_b32 v24, 4, v24
  v_add_u32 v218, 1310720, v24
  v_sub_u32 v25, s49, v22
  v_cndmask_b32 v25, v25, v22, vcc
  v_cvt_f32_u32 v25, v25
  v_cvt_f32_u32 v28, v23
  v_mul_f32 v216, 0x3d000000, v25
  v_mul_f32 v28, 4.0, v28
  v_mul_f32 v217, v28, v216
  v_lshl_add_u32 v24, s48, 5, v22
  v_sub_u32 v29, 0, v24
  v_and_b32 v29, 0xff, v29
  v_cndmask_b32 v29, v29, v24, vcc
  v_lshrrev_b32 v26, 5, v29
  v_mul_u32_u24 v26, 67552, v26
  v_lshl_add_u32 v29, v23, 7, v29
  v_add_u32 v29, v29, v26
  s_mul_i32 s50, s50, 4224
  s_add_u32 s50, s50, 6291456
  v_cmp_eq_u32 vcc, 0, v24
  v_lshl_add_u32 v29, v29, 2, s50
  v_mov_b32 v26, 0x7f000000
  v_cndmask_b32 v223, v29, v26, vcc
  s_waitcnt vmcnt(0)
  s_barrier
  buffer_store_dword v6, v1, s[32:35], s55 offen sc1
  buffer_store_dwordx4 v[80:83], v236, s[32:35], 0 offen sc1
  buffer_store_dwordx4 v[84:87], v236, s[32:35], s1 offen sc1
  buffer_load_dword v219, v234, s[24:27], 0 offen offset:384
  s_add_u32 m0, s58, 0
  s_lshl4_add_u32 s53, s72, 0
  s_nop 0
  buffer_load_dwordx4 v2, s[24:27], s53 offen offset:0 lds
  ds_read_b64_tr_b16 v[128:129], v233 offset:0
  ds_read_b64_tr_b16 v[130:131], v233 offset:2048
  ds_read_b64_tr_b16 v[132:133], v233 offset:4096
  ds_read_b64_tr_b16 v[134:135], v233 offset:6144
  ds_read_b64_tr_b16 v[136:137], v233 offset:8192
  ds_read_b64_tr_b16 v[138:139], v233 offset:10240
  ds_read_b64_tr_b16 v[140:141], v233 offset:12288
  ds_read_b64_tr_b16 v[142:143], v233 offset:14336
  ds_read_b64_tr_b16 v[144:145], v233 offset:16384
  ds_read_b64_tr_b16 v[146:147], v233 offset:18432
  ds_read_b64_tr_b16 v[148:149], v233 offset:20480
  ds_read_b64_tr_b16 v[150:151], v233 offset:22528
  ds_read_b64_tr_b16 v[152:153], v233 offset:24576
  ds_read_b64_tr_b16 v[154:155], v233 offset:26624
  s_lshl_b32 s55, s42, 7
  s_lshr_b32 s47, s41, 2
  s_add_u32 s55, s55, s47
  s_lshl_b32 s55, s55, 5
  s_and_b32 s47, s41, 3
  s_add_u32 s55, s55, s47
  s_lshl2_add_u32 s55, s55, 512
  s_lshl_b32 s47, s37, 5
  s_add_u32 s47, s36, s47
  s_lshl_b32 s47, s47, 4
  s_add_u32 s47, s47, 262144
  s_waitcnt lgkmcnt(10)
  v_mfma_f32_16x16x32_bf16 v[88:91], v[128:131], v[124:127], 0
  ds_read_b64_tr_b16 v[156:157], v233 offset:28672
  ds_read_b64_tr_b16 v[158:159], v233 offset:30720
  v_mfma_f32_16x16x32_bf16 v[88:91], v[132:135], v[124:127], v[88:91]
  ds_read_b64_tr_b16 v[160:161], v233 offset:32768
  ds_read_b64_tr_b16 v[162:163], v233 offset:34816
  s_waitcnt lgkmcnt(10)
  v_mfma_f32_16x16x32_bf16 v[88:91], v[136:139], v[124:127], v[88:91]
  buffer_load_dwordx4 v3, s[24:27], s53 offen offset:1024 lds
  ds_read_b64_tr_b16 v[164:165], v233 offset:36864
  ds_read_b64_tr_b16 v[166:167], v233 offset:38912
  v_mfma_f32_16x16x32_bf16 v[88:91], v[140:143], v[124:127], v[88:91]
  ds_read_b64_tr_b16 v[168:169], v233 offset:40960
  ds_read_b64_tr_b16 v[170:171], v233 offset:43008
  s_waitcnt lgkmcnt(10)
  v_mfma_f32_16x16x32_bf16 v[88:91], v[144:147], v[124:127], v[88:91]
  ds_read_b64_tr_b16 v[172:173], v233 offset:45056
  ds_read_b64_tr_b16 v[174:175], v233 offset:47104
  v_mfma_f32_16x16x32_bf16 v[88:91], v[148:151], v[124:127], v[88:91]
  buffer_load_dwordx4 v4, s[24:27], s53 offen offset:2048 lds
  ds_read_b64_tr_b16 v[176:177], v233 offset:49152
  ds_read_b64_tr_b16 v[178:179], v233 offset:51200
  s_waitcnt lgkmcnt(10)
  v_mfma_f32_16x16x32_bf16 v[88:91], v[152:155], v[124:127], v[88:91]
  ds_read_b64_tr_b16 v[180:181], v233 offset:53248
  ds_read_b64_tr_b16 v[182:183], v233 offset:55296
  v_mfma_f32_16x16x32_bf16 v[88:91], v[156:159], v[124:127], v[88:91]
  ds_read_b64_tr_b16 v[184:185], v233 offset:57344
  ds_read_b64_tr_b16 v[186:187], v233 offset:59392
  s_waitcnt lgkmcnt(10)
  v_mfma_f32_16x16x32_bf16 v[88:91], v[160:163], v[124:127], v[88:91]
  buffer_load_dwordx4 v5, s[24:27], s53 offen offset:3072 lds
  ds_read_b64_tr_b16 v[188:189], v233 offset:61440
  ds_read_b64_tr_b16 v[190:191], v233 offset:63488
  v_mfma_f32_16x16x32_bf16 v[88:91], v[164:167], v[124:127], v[88:91]
  ds_read_b64_tr_b16 v[128:129], v220 offset:0
  ds_read_b64_tr_b16 v[130:131], v220 offset:1536
  s_waitcnt lgkmcnt(10)
  v_mfma_f32_16x16x32_bf16 v[88:91], v[168:171], v[124:127], v[88:91]
  ds_read_b64_tr_b16 v[132:133], v220 offset:3072
  ds_read_b64_tr_b16 v[134:135], v220 offset:4608
  v_mfma_f32_16x16x32_bf16 v[88:91], v[172:175], v[124:127], v[88:91]
  s_add_u32 m0, s58, 4096
  s_lshl4_add_u32 s53, s72, 32768
  buffer_load_dwordx4 v2, s[24:27], s53 offen offset:0 lds
  ds_read_b64_tr_b16 v[136:137], v220 offset:6144
  ds_read_b64_tr_b16 v[138:139], v220 offset:7680
  s_waitcnt lgkmcnt(10)
  v_mfma_f32_16x16x32_bf16 v[88:91], v[176:179], v[124:127], v[88:91]
  ds_read_b64_tr_b16 v[140:141], v220 offset:9216
  ds_read_b64_tr_b16 v[142:143], v220 offset:10752
  v_mfma_f32_16x16x32_bf16 v[88:91], v[180:183], v[124:127], v[88:91]
  ds_read_b64_tr_b16 v[144:145], v220 offset:12288
  ds_read_b64_tr_b16 v[146:147], v220 offset:13824
  s_waitcnt lgkmcnt(10)
  v_mfma_f32_16x16x32_bf16 v[88:91], v[184:187], v[124:127], v[88:91]
  s_load_dwordx8 s[8:15], s[32:33], s59 glc
  buffer_load_dwordx4 v3, s[24:27], s53 offen offset:1024 lds
  ds_read_b64_tr_b16 v[148:149], v220 offset:15360
  ds_read_b64_tr_b16 v[150:151], v220 offset:16896
  v_mfma_f32_16x16x32_bf16 v[88:91], v[188:191], v[124:127], v[88:91]
  ds_read_b64_tr_b16 v[152:153], v220 offset:18432
  ds_read_b64_tr_b16 v[154:155], v220 offset:19968
  buffer_load_dwordx4 v4, s[24:27], s53 offen offset:2048 lds
  buffer_load_dwordx4 v5, s[24:27], s53 offen offset:3072 lds
  s_add_u32 m0, s58, 8192
  s_lshl4_add_u32 s53, s73, 0
  buffer_load_dwordx4 v2, s[24:27], s53 offen offset:0 lds
  buffer_load_dwordx4 v3, s[24:27], s53 offen offset:1024 lds
L_sp2:
  s_waitcnt lgkmcnt(0)
  s_xor_b64 s[8:9], s[8:9], s[6:7]
  s_xor_b64 s[10:11], s[10:11], s[6:7]
  s_xor_b64 s[12:13], s[12:13], s[6:7]
  s_xor_b64 s[14:15], s[14:15], s[6:7]
  s_or_b64 s[8:9], s[8:9], s[12:13]
  s_or_b64 s[10:11], s[10:11], s[14:15]
  s_or_b64 s[8:9], s[8:9], s[10:11]
  s_cbranch_scc0 L_sp2_done
  s_sub_u32 s46, s46, 1
  s_cmp_lt_i32 s46, 0
  s_cbranch_scc1 L_sp2_done
  s_load_dwordx8 s[8:15], s[32:33], s59 glc
  s_branch L_sp2
L_sp2_done:
  s_mov_b32 s59, s52
  buffer_load_dwordx4 a[0:3], v30, s[32:35], s64 offen offset:0 sc1
  buffer_load_dwordx4 a[4:7], v30, s[32:35], s64 offen offset:256 sc1
  v_mfma_f32_16x16x32_bf16 v[92:95], v[128:131], v[124:127], 0
  ds_read_b64_tr_b16 v[156:157], v220 offset:21504
  ds_read_b64_tr_b16 v[158:159], v220 offset:23040
  v_mfma_f32_16x16x32_bf16 v[92:95], v[132:135], v[124:127], v[92:95]
  ds_read_b64_tr_b16 v[160:161], v220 offset:24576
  ds_read_b64_tr_b16 v[162:163], v220 offset:26112
  v_mfma_f32_16x16x32_bf16 v[92:95], v[136:139], v[124:127], v[92:95]
  buffer_load_dwordx4 a[8:11], v30, s[32:35], s64 offen offset:2048 sc1
  ds_read_b64_tr_b16 v[164:165], v220 offset:27648
  ds_read_b64_tr_b16 v[166:167], v220 offset:29184
  v_mfma_f32_16x16x32_bf16 v[92:95], v[140:143], v[124:127], v[92:95]
  ds_read_b64_tr_b16 v[168:169], v220 offset:30720
  ds_read_b64_tr_b16 v[170:171], v220 offset:32256
  v_mfma_f32_16x16x32_bf16 v[92:95], v[144:147], v[124:127], v[92:95]
  ds_read_b64_tr_b16 v[172:173], v220 offset:33792
  ds_read_b64_tr_b16 v[174:175], v220 offset:35328
  v_mfma_f32_16x16x32_bf16 v[92:95], v[148:151], v[124:127], v[92:95]
  buffer_load_dwordx4 a[12:15], v30, s[32:35], s64 offen offset:2304 sc1
  ds_read_b64_tr_b16 v[176:177], v220 offset:36864
  ds_read_b64_tr_b16 v[178:179], v220 offset:38400
  s_waitcnt lgkmcnt(10)
  v_mfma_f32_16x16x32_bf16 v[92:95], v[152:155], v[124:127], v[92:95]
  ds_read_b64_tr_b16 v[180:181], v220 offset:39936
  ds_read_b64_tr_b16 v[182:183], v220 offset:41472
  v_mfma_f32_16x16x32_bf16 v[92:95], v[156:159], v[124:127], v[92:95]
  buffer_load_dwordx4 a[16:19], v30, s[32:35], s65 offen offset:0 sc1
  ds_read_b64_tr_b16 v[184:185], v220 offset:43008
  ds_read_b64_tr_b16 v[186:187], v220 offset:44544
  s_waitcnt lgkmcnt(10)
  v_mfma_f32_16x16x32_bf16 v[92:95], v[160:163], v[124:127], v[92:95]
  ds_read_b64_tr_b16 v[188:189], v220 offset:46080
  ds_read_b64_tr_b16 v[190:191], v220 offset:47616
  v_mfma_f32_16x16x32_bf16 v[92:95], v[164:167], v[124:127], v[92:95]
  s_waitcnt lgkmcnt(8)
  v_mfma_f32_16x16x32_bf16 v[92:95], v[168:171], v[124:127], v[92:95]
  buffer_load_dwordx4 a[20:23], v30, s[32:35], s65 offen offset:256 sc1
  v_mfma_f32_16x16x32_bf16 v[92:95], v[172:175], v[124:127], v[92:95]
  s_waitcnt lgkmcnt(4)
  v_mfma_f32_16x16x32_bf16 v[92:95], v[176:179], v[124:127], v[92:95]
  v_mfma_f32_16x16x32_bf16 v[92:95], v[180:183], v[124:127], v[92:95]
  buffer_load_dwordx4 a[24:27], v30, s[32:35], s65 offen offset:2048 sc1
  s_waitcnt lgkmcnt(0)
  v_mfma_f32_16x16x32_bf16 v[92:95], v[184:187], v[124:127], v[92:95]
  v_mfma_f32_16x16x32_bf16 v[92:95], v[188:191], v[124:127], v[92:95]
  buffer_load_dwordx4 a[28:31], v30, s[32:35], s65 offen offset:2304 sc1
  ds_read_b64_tr_b16 v[160:161], v228 offset:0
  ds_read_b64_tr_b16 v[162:163], v228 offset:2048
  ds_read_b64_tr_b16 v[164:165], v229 offset:0
  ds_read_b64_tr_b16 v[166:167], v229 offset:2048
  ds_read_b64_tr_b16 v[168:169], v230 offset:0
  buffer_load_dwordx4 a[32:35], v30, s[32:35], s66 offen offset:0 sc1
  ds_read_b64_tr_b16 v[170:171], v230 offset:2048
  ds_read_b64_tr_b16 v[172:173], v231 offset:0
  ds_read_b64_tr_b16 v[174:175], v231 offset:2048
  s_mov_b32 exec_lo, 0x00010001
  s_mov_b32 exec_hi, 0x00010001
  ds_write_b128 v18, v[88:91] offset:10240
  ds_write_b128 v18, v[92:95] offset:10496
  s_mov_b64 exec, -1
  ds_read_b64_tr_b16 v[176:177], v228 offset:4096
  buffer_load_dwordx4 a[36:39], v30, s[32:35], s66 offen offset:256 sc1
  ds_read_b64_tr_b16 v[178:179], v228 offset:6144
  ds_read_b64_tr_b16 v[180:181], v229 offset:4096
  ds_read_b64_tr_b16 v[182:183], v229 offset:6144
  ds_read_b64_tr_b16 v[184:185], v230 offset:4096
  ds_read_b64_tr_b16 v[186:187], v230 offset:6144
  buffer_load_dwordx4 a[40:43], v30, s[32:35], s66 offen offset:2048 sc1
  ds_read_b64_tr_b16 v[188:189], v231 offset:4096
  ds_read_b64_tr_b16 v[190:191], v231 offset:6144
  buffer_load_dwordx4 a[44:47], v30, s[32:35], s66 offen offset:2304 sc1
  s_waitcnt vmcnt(10) lgkmcnt(10)
  v_mfma_f32_16x16x32_bf16 v[32:35], v[160:163], a[0:3], 0
  ds_read_b64_tr_b16 v[192:193], v228 offset:8192
  buffer_load_dwordx4 a[48:51], v30, s[32:35], s67 offen offset:0 sc1
  ds_read_b64_tr_b16 a[128:129], v240 offset:0
  v_mfma_f32_16x16x32_bf16 v[48:51], v[160:163], a[4:7], 0
  ds_read_b64_tr_b16 v[194:195], v228 offset:10240
  ds_read_b64_tr_b16 a[132:133], v241 offset:0
  v_mfma_f32_16x16x32_bf16 v[36:39], v[164:167], a[0:3], 0
  ds_read_b64_tr_b16 v[196:197], v229 offset:8192
  ds_read_b64_tr_b16 a[136:137], v242 offset:0
  v_mfma_f32_16x16x32_bf16 v[52:55], v[164:167], a[4:7], 0
  ds_read_b64_tr_b16 v[198:199], v229 offset:10240
  ds_read_b64_tr_b16 a[140:141], v243 offset:0
  v_mfma_f32_16x16x32_bf16 v[40:43], v[168:171], a[0:3], 0
  ds_read_b64_tr_b16 v[200:201], v230 offset:8192
  buffer_load_dwordx4 a[52:55], v30, s[32:35], s67 offen offset:256 sc1
  ds_read_b64_tr_b16 a[130:131], v240 offset:2048
  v_mfma_f32_16x16x32_bf16 v[56:59], v[168:171], a[4:7], 0
  ds_read_b64_tr_b16 v[202:203], v230 offset:10240
  ds_read_b64_tr_b16 a[134:135], v241 offset:2048
  v_mfma_f32_16x16x32_bf16 v[44:47], v[172:175], a[0:3], 0
  ds_read_b64_tr_b16 v[204:205], v231 offset:8192
  ds_read_b64_tr_b16 a[138:139], v242 offset:2048
  v_mfma_f32_16x16x32_bf16 v[60:63], v[172:175], a[4:7], 0
  ds_read_b64_tr_b16 v[206:207], v231 offset:10240
  ds_read_b64_tr_b16 a[142:143], v243 offset:2048
  s_waitcnt vmcnt(10) lgkmcnt(15)
  v_mfma_f32_16x16x32_bf16 v[32:35], v[176:179], a[8:11], v[32:35]
  ds_read_b64_tr_b16 v[160:161], v228 offset:12288
  buffer_load_dwordx4 a[56:59], v30, s[32:35], s67 offen offset:2048 sc1
  ds_read_b64_tr_b16 a[144:145], v240 offset:4096
  v_mfma_f32_16x16x32_bf16 v[48:51], v[176:179], a[12:15], v[48:51]
  ds_read_b64_tr_b16 v[162:163], v228 offset:14336
  ds_read_b64_tr_b16 a[148:149], v241 offset:4096
  v_mfma_f32_16x16x32_bf16 v[36:39], v[180:183], a[8:11], v[36:39]
  ds_read_b64_tr_b16 v[164:165], v229 offset:12288
  ds_read_b64_tr_b16 a[152:153], v242 offset:4096
  v_mfma_f32_16x16x32_bf16 v[52:55], v[180:183], a[12:15], v[52:55]
  ds_read_b64_tr_b16 v[166:167], v229 offset:14336
  ds_read_b64_tr_b16 a[156:157], v243 offset:4096
  v_mfma_f32_16x16x32_bf16 v[40:43], v[184:187], a[8:11], v[40:43]
  ds_read_b64_tr_b16 v[168:169], v230 offset:12288
  buffer_load_dwordx4 a[60:63], v30, s[32:35], s67 offen offset:2304 sc1
  ds_read_b64_tr_b16 a[146:147], v240 offset:6144
  v_mfma_f32_16x16x32_bf16 v[56:59], v[184:187], a[12:15], v[56:59]
  ds_read_b64_tr_b16 v[170:171], v230 offset:14336
  ds_read_b64_tr_b16 a[150:151], v241 offset:6144
  v_mfma_f32_16x16x32_bf16 v[44:47], v[188:191], a[8:11], v[44:47]
  ds_read_b64_tr_b16 v[172:173], v231 offset:12288
  ds_read_b64_tr_b16 a[154:155], v242 offset:6144
  v_mfma_f32_16x16x32_bf16 v[60:63], v[188:191], a[12:15], v[60:63]
  ds_read_b64_tr_b16 v[174:175], v231 offset:14336
  ds_read_b64_tr_b16 a[158:159], v243 offset:6144
  s_waitcnt vmcnt(10) lgkmcnt(15)
  v_mfma_f32_16x16x32_bf16 v[32:35], v[192:195], a[16:19], v[32:35]
  ds_read_b64_tr_b16 v[176:177], v228 offset:16384
  buffer_load_dword v208, v31, s[32:35], 0 offen offset:0 sc1
  buffer_load_dword v209, v31, s[32:35], 0 offen offset:256 sc1
  ds_read_b64_tr_b16 a[160:161], v240 offset:8192
  v_mfma_f32_16x16x32_bf16 v[48:51], v[192:195], a[20:23], v[48:51]
  ds_read_b64_tr_b16 v[178:179], v228 offset:18432
  ds_read_b64_tr_b16 a[164:165], v241 offset:8192
  v_mfma_f32_16x16x32_bf16 v[36:39], v[196:199], a[16:19], v[36:39]
  ds_read_b64_tr_b16 v[180:181], v229 offset:16384
  ds_read_b64_tr_b16 a[168:169], v242 offset:8192
  v_mfma_f32_16x16x32_bf16 v[52:55], v[196:199], a[20:23], v[52:55]
  ds_read_b64_tr_b16 v[182:183], v229 offset:18432
  ds_read_b64_tr_b16 a[172:173], v243 offset:8192
  v_mfma_f32_16x16x32_bf16 v[40:43], v[200:203], a[16:19], v[40:43]
  ds_read_b64_tr_b16 v[184:185], v230 offset:16384
  buffer_load_dword v210, v31, s[32:35], 0 offen offset:512 sc1
  buffer_load_dword v211, v31, s[32:35], 0 offen offset:768 sc1
  s_barrier
  buffer_store_dword v6, v237, s[32:35], s47 offen sc1
  v_mfma_f32_16x16x32_bf16 v[56:59], v[200:203], a[20:23], v[56:59]
  ds_read_b64_tr_b16 v[186:187], v230 offset:18432
  ds_read_b128 v[88:91], v19 offset:10240
  v_mfma_f32_16x16x32_bf16 v[44:47], v[204:207], a[16:19], v[44:47]
  ds_read_b64_tr_b16 v[188:189], v231 offset:16384
  ds_read_b128 v[92:95], v19 offset:10304
  v_mfma_f32_16x16x32_bf16 v[60:63], v[204:207], a[20:23], v[60:63]
  ds_read_b64_tr_b16 v[190:191], v231 offset:18432
  ds_read_b128 v[96:99], v19 offset:10368
  s_waitcnt vmcnt(13) lgkmcnt(15)
  v_mfma_f32_16x16x32_bf16 v[32:35], v[160:163], a[24:27], v[32:35]
  ds_read_b64_tr_b16 v[192:193], v228 offset:20480
  buffer_load_dword v212, v31, s[32:35], 0 offen offset:1024 sc1
  buffer_load_dword v213, v31, s[32:35], 0 offen offset:1280 sc1
  ds_read_b128 v[100:103], v19 offset:10432
  v_mfma_f32_16x16x32_bf16 v[48:51], v[160:163], a[28:31], v[48:51]
  ds_read_b64_tr_b16 v[194:195], v228 offset:22528
  ds_read_b128 v[104:107], v19 offset:10496
  v_mfma_f32_16x16x32_bf16 v[36:39], v[164:167], a[24:27], v[36:39]
  ds_read_b64_tr_b16 v[196:197], v229 offset:20480
  ds_read_b128 v[108:111], v19 offset:10560
  v_mfma_f32_16x16x32_bf16 v[52:55], v[164:167], a[28:31], v[52:55]
  ds_read_b64_tr_b16 v[198:199], v229 offset:22528
  ds_read_b128 v[112:115], v19 offset:10624
  v_mfma_f32_16x16x32_bf16 v[40:43], v[168:171], a[24:27], v[40:43]
  ds_read_b64_tr_b16 v[200:201], v230 offset:20480
  buffer_load_dword v214, v31, s[32:35], 0 offen offset:1536 sc1
  buffer_load_dword v215, v31, s[32:35], 0 offen offset:1792 sc1
  v_mfma_f32_16x16x32_bf16 v[56:59], v[168:171], a[28:31], v[56:59]
  ds_read_b64_tr_b16 v[202:203], v230 offset:22528
  v_mfma_f32_16x16x32_bf16 v[44:47], v[172:175], a[24:27], v[44:47]
  ds_read_b64_tr_b16 v[204:205], v231 offset:20480
  v_mfma_f32_16x16x32_bf16 v[60:63], v[172:175], a[28:31], v[60:63]
  ds_read_b64_tr_b16 v[206:207], v231 offset:22528
  s_waitcnt vmcnt(15) lgkmcnt(13)
  v_mfma_f32_16x16x32_bf16 v[32:35], v[176:179], a[32:35], v[32:35]
  ds_read_b64_tr_b16 v[160:161], v228 offset:24576
  buffer_load_dwordx4 a[64:67], v30, s[32:35], s68 offen offset:0 sc1
  v_mfma_f32_16x16x32_bf16 v[48:51], v[176:179], a[36:39], v[48:51]
  ds_read_b64_tr_b16 v[162:163], v228 offset:26624
  v_mfma_f32_16x16x32_bf16 v[36:39], v[180:183], a[32:35], v[36:39]
  ds_read_b64_tr_b16 v[164:165], v229 offset:24576
  v_mfma_f32_16x16x32_bf16 v[52:55], v[180:183], a[36:39], v[52:55]
  ds_read_b64_tr_b16 v[166:167], v229 offset:26624
  v_mfma_f32_16x16x32_bf16 v[40:43], v[184:187], a[32:35], v[40:43]
  ds_read_b64_tr_b16 v[168:169], v230 offset:24576
  buffer_load_dwordx4 a[68:71], v30, s[32:35], s68 offen offset:256 sc1
  v_mfma_f32_16x16x32_bf16 v[56:59], v[184:187], a[36:39], v[56:59]
  ds_read_b64_tr_b16 v[170:171], v230 offset:26624
  v_mfma_f32_16x16x32_bf16 v[44:47], v[188:191], a[32:35], v[44:47]
  ds_read_b64_tr_b16 v[172:173], v231 offset:24576
  v_mfma_f32_16x16x32_bf16 v[60:63], v[188:191], a[36:39], v[60:63]
  ds_read_b64_tr_b16 v[174:175], v231 offset:26624
  s_waitcnt vmcnt(15) lgkmcnt(8)
  v_mfma_f32_16x16x32_bf16 v[32:35], v[192:195], a[40:43], v[32:35]
  ds_read_b64_tr_b16 v[176:177], v228 offset:28672
  buffer_load_dwordx4 a[72:75], v30, s[32:35], s68 offen offset:2048 sc1
  v_mfma_f32_16x16x32_bf16 v[48:51], v[192:195], a[44:47], v[48:51]
  ds_read_b64_tr_b16 v[178:179], v228 offset:30720
  v_mfma_f32_16x16x32_bf16 v[36:39], v[196:199], a[40:43], v[36:39]
  ds_read_b64_tr_b16 v[180:181], v229 offset:28672
  v_mfma_f32_16x16x32_bf16 v[52:55], v[196:199], a[44:47], v[52:55]
  ds_read_b64_tr_b16 v[182:183], v229 offset:30720
  v_mfma_f32_16x16x32_bf16 v[40:43], v[200:203], a[40:43], v[40:43]
  ds_read_b64_tr_b16 v[184:185], v230 offset:28672
  buffer_load_dwordx4 a[76:79], v30, s[32:35], s68 offen offset:2304 sc1
  v_mfma_f32_16x16x32_bf16 v[56:59], v[200:203], a[44:47], v[56:59]
  ds_read_b64_tr_b16 v[186:187], v230 offset:30720
  v_mfma_f32_16x16x32_bf16 v[44:47], v[204:207], a[40:43], v[44:47]
  ds_read_b64_tr_b16 v[188:189], v231 offset:28672
  v_mfma_f32_16x16x32_bf16 v[60:63], v[204:207], a[44:47], v[60:63]
  ds_read_b64_tr_b16 v[190:191], v231 offset:30720
  s_waitcnt vmcnt(15) lgkmcnt(8)
  v_mfma_f32_16x16x32_bf16 v[32:35], v[160:163], a[48:51], v[32:35]
  ds_read_b64_tr_b16 v[192:193], v228 offset:32768
  buffer_load_dwordx4 a[80:83], v30, s[32:35], s69 offen offset:0 sc1
  v_mfma_f32_16x16x32_bf16 v[48:51], v[160:163], a[52:55], v[48:51]
  ds_read_b64_tr_b16 v[194:195], v228 offset:34816
  v_mfma_f32_16x16x32_bf16 v[36:39], v[164:167], a[48:51], v[36:39]
  ds_read_b64_tr_b16 v[196:197], v229 offset:32768
  v_mfma_f32_16x16x32_bf16 v[52:55], v[164:167], a[52:55], v[52:55]
  ds_read_b64_tr_b16 v[198:199], v229 offset:34816
  v_mfma_f32_16x16x32_bf16 v[40:43], v[168:171], a[48:51], v[40:43]
  ds_read_b64_tr_b16 v[200:201], v230 offset:32768
  buffer_load_dwordx4 a[84:87], v30, s[32:35], s69 offen offset:256 sc1
  v_mfma_f32_16x16x32_bf16 v[56:59], v[168:171], a[52:55], v[56:59]
  ds_read_b64_tr_b16 v[202:203], v230 offset:34816
  v_mfma_f32_16x16x32_bf16 v[44:47], v[172:175], a[48:51], v[44:47]
  ds_read_b64_tr_b16 v[204:205], v231 offset:32768
  v_mfma_f32_16x16x32_bf16 v[60:63], v[172:175], a[52:55], v[60:63]
  ds_read_b64_tr_b16 v[206:207], v231 offset:34816
  s_waitcnt vmcnt(15) lgkmcnt(8)
  v_mfma_f32_16x16x32_bf16 v[32:35], v[176:179], a[56:59], v[32:35]
  ds_read_b64_tr_b16 v[160:161], v228 offset:36864
  buffer_load_dwordx4 a[88:91], v30, s[32:35], s69 offen offset:2048 sc1
  v_mfma_f32_16x16x32_bf16 v[48:51], v[176:179], a[60:63], v[48:51]
  ds_read_b64_tr_b16 v[162:163], v228 offset:38912
  v_mfma_f32_16x16x32_bf16 v[36:39], v[180:183], a[56:59], v[36:39]
  ds_read_b64_tr_b16 v[164:165], v229 offset:36864
  v_mfma_f32_16x16x32_bf16 v[52:55], v[180:183], a[60:63], v[52:55]
  ds_read_b64_tr_b16 v[166:167], v229 offset:38912
  v_mfma_f32_16x16x32_bf16 v[40:43], v[184:187], a[56:59], v[40:43]
  ds_read_b64_tr_b16 v[168:169], v230 offset:36864
  buffer_load_dwordx4 a[92:95], v30, s[32:35], s69 offen offset:2304 sc1
  v_mfma_f32_16x16x32_bf16 v[56:59], v[184:187], a[60:63], v[56:59]
  ds_read_b64_tr_b16 v[170:171], v230 offset:38912
  v_mfma_f32_16x16x32_bf16 v[44:47], v[188:191], a[56:59], v[44:47]
  ds_read_b64_tr_b16 v[172:173], v231 offset:36864
  v_mfma_f32_16x16x32_bf16 v[60:63], v[188:191], a[60:63], v[60:63]
  ds_read_b64_tr_b16 v[174:175], v231 offset:38912
  s_waitcnt vmcnt(6) lgkmcnt(8)
  v_mfma_f32_16x16x32_bf16 v[32:35], v[192:195], a[64:67], v[32:35]
  ds_read_b64_tr_b16 v[176:177], v228 offset:40960
  buffer_load_dwordx4 a[96:99], v30, s[32:35], s70 offen offset:0 sc1
  v_mfma_f32_16x16x32_bf16 v[48:51], v[192:195], a[68:71], v[48:51]
  ds_read_b64_tr_b16 v[178:179], v228 offset:43008
  v_mfma_f32_16x16x32_bf16 v[36:39], v[196:199], a[64:67], v[36:39]
  ds_read_b64_tr_b16 v[180:181], v229 offset:40960
  v_mfma_f32_16x16x32_bf16 v[52:55], v[196:199], a[68:71], v[52:55]
  ds_read_b64_tr_b16 v[182:183], v229 offset:43008
  v_mfma_f32_16x16x32_bf16 v[40:43], v[200:203], a[64:67], v[40:43]
  ds_read_b64_tr_b16 v[184:185], v230 offset:40960
  buffer_load_dwordx4 a[100:103], v30, s[32:35], s70 offen offset:256 sc1
  v_mfma_f32_16x16x32_bf16 v[56:59], v[200:203], a[68:71], v[56:59]
  ds_read_b64_tr_b16 v[186:187], v230 offset:43008
  v_mfma_f32_16x16x32_bf16 v[44:47], v[204:207], a[64:67], v[44:47]
  ds_read_b64_tr_b16 v[188:189], v231 offset:40960
  v_mfma_f32_16x16x32_bf16 v[60:63], v[204:207], a[68:71], v[60:63]
  ds_read_b64_tr_b16 v[190:191], v231 offset:43008
  s_waitcnt vmcnt(6) lgkmcnt(8)
  v_mfma_f32_16x16x32_bf16 v[32:35], v[160:163], a[72:75], v[32:35]
  ds_read_b64_tr_b16 v[192:193], v228 offset:45056
  buffer_load_dwordx4 a[104:107], v30, s[32:35], s70 offen offset:2048 sc1
  v_mfma_f32_16x16x32_bf16 v[48:51], v[160:163], a[76:79], v[48:51]
  ds_read_b64_tr_b16 v[194:195], v228 offset:47104
  v_add_f32 v208, v208, v212
  v_mfma_f32_16x16x32_bf16 v[36:39], v[164:167], a[72:75], v[36:39]
  ds_read_b64_tr_b16 v[196:197], v229 offset:45056
L_pad4:
  s_cbranch_execz L_hopA
  v_add_f32 v209, v209, v213
  v_mfma_f32_16x16x32_bf16 v[52:55], v[164:167], a[76:79], v[52:55]
  ds_read_b64_tr_b16 v[198:199], v229 offset:47104
  v_add_f32 v210, v210, v214
  v_mfma_f32_16x16x32_bf16 v[40:43], v[168:171], a[72:75], v[40:43]
  ds_read_b64_tr_b16 v[200:201], v230 offset:45056
  buffer_load_dwordx4 a[108:111], v30, s[32:35], s70 offen offset:2304 sc1
  v_add_f32 v211, v211, v215
  v_mfma_f32_16x16x32_bf16 v[56:59], v[168:171], a[76:79], v[56:59]
  ds_read_b64_tr_b16 v[202:203], v230 offset:47104
  v_add_f32 v208, v208, v209
  v_mfma_f32_16x16x32_bf16 v[44:47], v[172:175], a[72:75], v[44:47]
  ds_read_b64_tr_b16 v[204:205], v231 offset:45056
  v_add_f32 v210, v210, v211
  v_mfma_f32_16x16x32_bf16 v[60:63], v[172:175], a[76:79], v[60:63]
  ds_read_b64_tr_b16 v[206:207], v231 offset:47104
  v_add_f32 v16, v208, v210
  s_waitcnt vmcnt(6) lgkmcnt(8)
  v_mfma_f32_16x16x32_bf16 v[32:35], v[176:179], a[80:83], v[32:35]
  ds_read_b64_tr_b16 v[160:161], v228 offset:49152
  buffer_load_dwordx4 a[112:115], v30, s[32:35], s71 offen offset:0 sc1
  v_mov_b32 v17, v16
  v_mfma_f32_16x16x32_bf16 v[48:51], v[176:179], a[84:87], v[48:51]
  ds_read_b64_tr_b16 v[162:163], v228 offset:51200
  v_permlane32_swap_b32 v16, v17
  v_mfma_f32_16x16x32_bf16 v[36:39], v[180:183], a[80:83], v[36:39]
  ds_read_b64_tr_b16 v[164:165], v229 offset:49152
  v_mul_f32 v16, 0xbb000000, v16
  v_mfma_f32_16x16x32_bf16 v[52:55], v[180:183], a[84:87], v[52:55]
  ds_read_b64_tr_b16 v[166:167], v229 offset:51200
  v_mul_f32 v17, 0x3b000000, v17
  v_mfma_f32_16x16x32_bf16 v[40:43], v[184:187], a[80:83], v[40:43]
  ds_read_b64_tr_b16 v[168:169], v230 offset:49152
  buffer_load_dwordx4 a[116:119], v30, s[32:35], s71 offen offset:256 sc1
  v_fma_f32 v17, -v16, v16, v17
  v_mfma_f32_16x16x32_bf16 v[56:59], v[184:187], a[84:87], v[56:59]
  ds_read_b64_tr_b16 v[170:171], v230 offset:51200
  v_max_f32 v17, 0, v17
  v_mfma_f32_16x16x32_bf16 v[44:47], v[188:191], a[80:83], v[44:47]
  ds_read_b64_tr_b16 v[172:173], v231 offset:49152
  v_add_f32 v17, 0x3727c5ac, v17
  v_mfma_f32_16x16x32_bf16 v[60:63], v[188:191], a[84:87], v[60:63]
  ds_read_b64_tr_b16 v[174:175], v231 offset:51200
  v_rsq_f32 v25, v17
  s_waitcnt vmcnt(6) lgkmcnt(8)
  v_mfma_f32_16x16x32_bf16 v[32:35], v[192:195], a[88:91], v[32:35]
  ds_read_b64_tr_b16 v[176:177], v228 offset:53248
  buffer_load_dwordx4 a[120:123], v30, s[32:35], s71 offen offset:2048 sc1
  v_sqrt_f32 v17, v17
  v_mfma_f32_16x16x32_bf16 v[48:51], v[192:195], a[92:95], v[48:51]
  ds_read_b64_tr_b16 v[178:179], v228 offset:55296
  v_mov_b32 v26, v16
  v_mfma_f32_16x16x32_bf16 v[36:39], v[196:199], a[88:91], v[36:39]
  ds_read_b64_tr_b16 v[180:181], v229 offset:53248
  v_mul_f32 v24, v25, v25
  v_mfma_f32_16x16x32_bf16 v[52:55], v[196:199], a[92:95], v[52:55]
  ds_read_b64_tr_b16 v[182:183], v229 offset:55296
  v_mul_f32 v25, 0xc0135761, v25
  v_mfma_f32_16x16x32_bf16 v[40:43], v[200:203], a[88:91], v[40:43]
  ds_read_b64_tr_b16 v[184:185], v230 offset:53248
  buffer_load_dwordx4 a[124:127], v30, s[32:35], s71 offen offset:2304 sc1
  v_mul_f32 v24, 0x3d372713, v24
  v_mfma_f32_16x16x32_bf16 v[56:59], v[200:203], a[92:95], v[56:59]
  ds_read_b64_tr_b16 v[186:187], v230 offset:55296
  s_add_u32 m0, s58, 0
  v_mul_f32 v24, v24, v25
  v_mfma_f32_16x16x32_bf16 v[44:47], v[204:207], a[88:91], v[44:47]
  ds_read_b64_tr_b16 v[188:189], v231 offset:53248
  s_lshl4_add_u32 s53, s73, 16384
  v_mov_b32 v27, v17
  v_mfma_f32_16x16x32_bf16 v[60:63], v[204:207], a[92:95], v[60:63]
  ds_read_b64_tr_b16 v[190:191], v231 offset:55296
  v_mov_b32 v29, v25
  s_waitcnt vmcnt(6) lgkmcnt(8)
  v_mfma_f32_16x16x32_bf16 v[32:35], v[160:163], a[96:99], v[32:35]
  ds_read_b64_tr_b16 v[192:193], v228 offset:57344
  buffer_load_dwordx4 v2, s[24:27], s53 offen offset:0 lds
  v_mov_b32 v28, v24
  v_mfma_f32_16x16x32_bf16 v[48:51], v[160:163], a[100:103], v[48:51]
  ds_read_b64_tr_b16 v[194:195], v228 offset:59392
  v_permlane16_swap_b32 v16, v26
  v_mfma_f32_16x16x32_bf16 v[36:39], v[164:167], a[96:99], v[36:39]
  ds_read_b64_tr_b16 v[196:197], v229 offset:57344
  v_permlane16_swap_b32 v17, v27
  v_mfma_f32_16x16x32_bf16 v[52:55], v[164:167], a[100:103], v[52:55]
  ds_read_b64_tr_b16 v[198:199], v229 offset:59392
  v_permlane16_swap_b32 v25, v29
  v_mfma_f32_16x16x32_bf16 v[40:43], v[168:171], a[96:99], v[40:43]
  ds_read_b64_tr_b16 v[200:201], v230 offset:57344
  buffer_load_dwordx4 v3, s[24:27], s53 offen offset:1024 lds
  v_permlane16_swap_b32 v24, v28
  v_mfma_f32_16x16x32_bf16 v[56:59], v[168:171], a[100:103], v[56:59]
  ds_read_b64_tr_b16 v[202:203], v230 offset:59392
  v_mul_f32 v64, v104, v16
  v_mfma_f32_16x16x32_bf16 v[44:47], v[172:175], a[96:99], v[44:47]
  ds_read_b64_tr_b16 v[204:205], v231 offset:57344
  v_mul_f32 v65, v105, v16
  v_mfma_f32_16x16x32_bf16 v[60:63], v[172:175], a[100:103], v[60:63]
  ds_read_b64_tr_b16 v[206:207], v231 offset:59392
  v_mul_f32 v66, v106, v16
  s_waitcnt vmcnt(6) lgkmcnt(8)
  v_mfma_f32_16x16x32_bf16 v[32:35], v[176:179], a[104:107], v[32:35]
  ds_read_b64_tr_b16 v[160:161], v228 offset:61440
  buffer_load_dwordx4 v4, s[24:27], s53 offen offset:2048 lds
  v_mul_f32 v67, v107, v16
  v_mfma_f32_16x16x32_bf16 v[48:51], v[176:179], a[108:111], v[48:51]
  ds_read_b64_tr_b16 v[162:163], v228 offset:63488
  v_mul_f32 v68, v108, v16
  v_mfma_f32_16x16x32_bf16 v[36:39], v[180:183], a[104:107], v[36:39]
  ds_read_b64_tr_b16 v[164:165], v229 offset:61440
  v_mul_f32 v69, v109, v16
  v_mfma_f32_16x16x32_bf16 v[52:55], v[180:183], a[108:111], v[52:55]
  ds_read_b64_tr_b16 v[166:167], v229 offset:63488
  v_mul_f32 v70, v110, v16
  v_mfma_f32_16x16x32_bf16 v[40:43], v[184:187], a[104:107], v[40:43]
  ds_read_b64_tr_b16 v[168:169], v230 offset:61440
  buffer_load_dwordx4 v5, s[24:27], s53 offen offset:3072 lds
  v_mul_f32 v71, v111, v16
  v_mfma_f32_16x16x32_bf16 v[56:59], v[184:187], a[108:111], v[56:59]
  ds_read_b64_tr_b16 v[170:171], v230 offset:63488
  s_add_u32 m0, s58, 4096
  v_mul_f32 v72, v112, v16
  v_mfma_f32_16x16x32_bf16 v[44:47], v[188:191], a[104:107], v[44:47]
  ds_read_b64_tr_b16 v[172:173], v231 offset:61440
  s_lshl4_add_u32 s53, s73, 49152
  v_mul_f32 v73, v113, v16
  v_mfma_f32_16x16x32_bf16 v[60:63], v[188:191], a[108:111], v[60:63]
  ds_read_b64_tr_b16 v[174:175], v231 offset:63488
  v_mul_f32 v74, v114, v16
  s_waitcnt vmcnt(6) lgkmcnt(8)
  v_mfma_f32_16x16x32_bf16 v[32:35], v[192:195], a[112:115], v[32:35]
  buffer_load_dwordx4 v2, s[24:27], s53 offen offset:0 lds
  v_mul_f32 v75, v115, v16
  v_mfma_f32_16x16x32_bf16 v[48:51], v[192:195], a[116:119], v[48:51]
  v_mul_f32 v76, v104, v26
  v_mfma_f32_16x16x32_bf16 v[36:39], v[196:199], a[112:115], v[36:39]
  v_mul_f32 v77, v105, v26
  v_mfma_f32_16x16x32_bf16 v[52:55], v[196:199], a[116:119], v[52:55]
  v_mul_f32 v78, v106, v26
  v_mfma_f32_16x16x32_bf16 v[40:43], v[200:203], a[112:115], v[40:43]
  buffer_load_dwordx4 v3, s[24:27], s53 offen offset:1024 lds
  v_mul_f32 v79, v107, v26
  v_mfma_f32_16x16x32_bf16 v[56:59], v[200:203], a[116:119], v[56:59]
  v_mul_f32 v80, v108, v26
  v_mfma_f32_16x16x32_bf16 v[44:47], v[204:207], a[112:115], v[44:47]
  v_mul_f32 v81, v109, v26
  v_mfma_f32_16x16x32_bf16 v[60:63], v[204:207], a[116:119], v[60:63]
  v_mul_f32 v82, v110, v26
  s_waitcnt vmcnt(6) lgkmcnt(0)
  v_mfma_f32_16x16x32_bf16 v[32:35], v[160:163], a[120:123], v[32:35]
  buffer_load_dwordx4 v4, s[24:27], s53 offen offset:2048 lds
  v_mul_f32 v83, v111, v26
  v_mfma_f32_16x16x32_bf16 v[48:51], v[160:163], a[124:127], v[48:51]
  v_mul_f32 v84, v112, v26
  v_mfma_f32_16x16x32_bf16 v[36:39], v[164:167], a[120:123], v[36:39]
  v_mul_f32 v85, v113, v26
  v_mfma_f32_16x16x32_bf16 v[52:55], v[164:167], a[124:127], v[52:55]
  v_mul_f32 v86, v114, v26
  v_mfma_f32_16x16x32_bf16 v[40:43], v[168:171], a[120:123], v[40:43]
  buffer_load_dwordx4 v5, s[24:27], s53 offen offset:3072 lds
  v_mul_f32 v87, v115, v26
  v_mfma_f32_16x16x32_bf16 v[56:59], v[168:171], a[124:127], v[56:59]
  s_add_u32 m0, s58, 8192
  v_mfma_f32_16x16x32_bf16 v[44:47], v[172:175], a[120:123], v[44:47]
  s_lshl4_add_u32 s53, s74, 16384
  v_mfma_f32_16x16x32_bf16 v[60:63], v[172:175], a[124:127], v[60:63]
  buffer_load_dwordx4 v2, s[24:27], s53 offen offset:0 lds
  buffer_load_dwordx4 v3, s[24:27], s53 offen offset:1024 lds
  s_barrier
  s_add_u32 m0, s57, 0
  s_nop 0
  s_lshl4_add_u32 s53, s74, 32768
  buffer_load_dwordx4 v2, s[24:27], s53 offen offset:0 lds
  buffer_load_dwordx4 v3, s[24:27], s53 offen offset:1024 lds
  buffer_load_dwordx4 v4, s[24:27], s53 offen offset:2048 lds
  buffer_load_dwordx4 v5, s[24:27], s53 offen offset:3072 lds
  v_pk_fma_f32 v[32:33], v[88:89], v[16:17], v[32:33] op_sel_hi:[1,0,1]
  v_pk_fma_f32 v[34:35], v[90:91], v[16:17], v[34:35] op_sel_hi:[1,0,1]
  v_pk_fma_f32 v[36:37], v[92:93], v[16:17], v[36:37] op_sel_hi:[1,0,1]
  v_pk_fma_f32 v[38:39], v[94:95], v[16:17], v[38:39] op_sel_hi:[1,0,1]
  v_pk_mul_f32 v[128:129], v[32:33], v[32:33]
  v_pk_mul_f32 v[130:131], v[34:35], v[34:35]
  v_pk_mul_f32 v[132:133], v[36:37], v[36:37]
  v_pk_mul_f32 v[134:135], v[38:39], v[38:39]
  v_pk_fma_f32 v[128:129], v[128:129], v[24:25], v[24:25] op_sel:[0,0,1] op_sel_hi:[1,0,1]
  v_pk_fma_f32 v[130:131], v[130:131], v[24:25], v[24:25] op_sel:[0,0,1] op_sel_hi:[1,0,1]
  v_pk_fma_f32 v[132:133], v[132:133], v[24:25], v[24:25] op_sel:[0,0,1] op_sel_hi:[1,0,1]
  v_pk_fma_f32 v[134:135], v[134:135], v[24:25], v[24:25] op_sel:[0,0,1] op_sel_hi:[1,0,1]
  v_pk_mul_f32 v[128:129], v[128:129], v[32:33]
  v_exp_f32 v128, v128
  v_exp_f32 v129, v129
  v_pk_mul_f32 v[130:131], v[130:131], v[34:35]
  v_exp_f32 v130, v130
  v_exp_f32 v131, v131
  v_pk_mul_f32 v[132:133], v[132:133], v[36:37]
  v_exp_f32 v132, v132
  v_exp_f32 v133, v133
  v_pk_mul_f32 v[134:135], v[134:135], v[38:39]
  v_exp_f32 v134, v134
  v_exp_f32 v135, v135
  v_pk_fma_f32 v[128:129], v[128:129], v[16:17], v[16:17] op_sel:[0,1,1] op_sel_hi:[1,1,1]
  v_rcp_f32 v128, v128
  v_rcp_f32 v129, v129
  v_pk_fma_f32 v[130:131], v[130:131], v[16:17], v[16:17] op_sel:[0,1,1] op_sel_hi:[1,1,1]
  v_rcp_f32 v130, v130
  v_rcp_f32 v131, v131
  v_pk_fma_f32 v[132:133], v[132:133], v[16:17], v[16:17] op_sel:[0,1,1] op_sel_hi:[1,1,1]
  v_rcp_f32 v132, v132
  v_rcp_f32 v133, v133
  v_pk_fma_f32 v[134:135], v[134:135], v[16:17], v[16:17] op_sel:[0,1,1] op_sel_hi:[1,1,1]
  v_rcp_f32 v134, v134
  v_rcp_f32 v135, v135
  v_pk_mul_f32 v[128:129], v[128:129], v[32:33]
  v_pk_mul_f32 v[130:131], v[130:131], v[34:35]
  v_pk_mul_f32 v[132:133], v[132:133], v[36:37]
  v_pk_mul_f32 v[134:135], v[134:135], v[38:39]
  v_cvt_pk_bf16_f32 v144, v128, v129
  v_cvt_pk_bf16_f32 v145, v130, v131
  v_cvt_pk_bf16_f32 v146, v132, v133
  v_cvt_pk_bf16_f32 v147, v134, v135
  buffer_store_dwordx4 v[144:147], v238, s[32:35], 0 offen offset:0 sc1
  s_add_u32 m0, s57, 4096
  s_lshl4_add_u32 s53, s75, 0
  s_nop 0
  buffer_load_dwordx4 v2, s[24:27], s53 offen offset:0 lds
  buffer_load_dwordx4 v3, s[24:27], s53 offen offset:1024 lds
  buffer_load_dwordx4 v4, s[24:27], s53 offen offset:2048 lds
  buffer_load_dwordx4 v5, s[24:27], s53 offen offset:3072 lds
  v_pk_fma_f32 v[48:49], v[88:89], v[26:27], v[48:49] op_sel_hi:[1,0,1]
  v_pk_fma_f32 v[50:51], v[90:91], v[26:27], v[50:51] op_sel_hi:[1,0,1]
  v_pk_fma_f32 v[52:53], v[92:93], v[26:27], v[52:53] op_sel_hi:[1,0,1]
  v_pk_fma_f32 v[54:55], v[94:95], v[26:27], v[54:55] op_sel_hi:[1,0,1]
  v_pk_mul_f32 v[136:137], v[48:49], v[48:49]
  v_pk_mul_f32 v[138:139], v[50:51], v[50:51]
  v_pk_mul_f32 v[140:141], v[52:53], v[52:53]
  v_pk_mul_f32 v[142:143], v[54:55], v[54:55]
  v_pk_fma_f32 v[136:137], v[136:137], v[28:29], v[28:29] op_sel:[0,0,1] op_sel_hi:[1,0,1]
  v_pk_fma_f32 v[138:139], v[138:139], v[28:29], v[28:29] op_sel:[0,0,1] op_sel_hi:[1,0,1]
  v_pk_fma_f32 v[140:141], v[140:141], v[28:29], v[28:29] op_sel:[0,0,1] op_sel_hi:[1,0,1]
  v_pk_fma_f32 v[142:143], v[142:143], v[28:29], v[28:29] op_sel:[0,0,1] op_sel_hi:[1,0,1]
  v_pk_mul_f32 v[136:137], v[136:137], v[48:49]
  v_exp_f32 v136, v136
  v_exp_f32 v137, v137
  v_pk_mul_f32 v[138:139], v[138:139], v[50:51]
  v_exp_f32 v138, v138
  v_exp_f32 v139, v139
  v_pk_mul_f32 v[140:141], v[140:141], v[52:53]
  v_exp_f32 v140, v140
  v_exp_f32 v141, v141
  v_pk_mul_f32 v[142:143], v[142:143], v[54:55]
  v_exp_f32 v142, v142
  v_exp_f32 v143, v143
  v_pk_fma_f32 v[136:137], v[136:137], v[26:27], v[26:27] op_sel:[0,1,1] op_sel_hi:[1,1,1]
  v_rcp_f32 v136, v136
  v_rcp_f32 v137, v137
  v_pk_fma_f32 v[138:139], v[138:139], v[26:27], v[26:27] op_sel:[0,1,1] op_sel_hi:[1,1,1]
  v_rcp_f32 v138, v138
  v_rcp_f32 v139, v139
  v_pk_fma_f32 v[140:141], v[140:141], v[26:27], v[26:27] op_sel:[0,1,1] op_sel_hi:[1,1,1]
  v_rcp_f32 v140, v140
  v_rcp_f32 v141, v141
  v_pk_fma_f32 v[142:143], v[142:143], v[26:27], v[26:27] op_sel:[0,1,1] op_sel_hi:[1,1,1]
  v_rcp_f32 v142, v142
  v_rcp_f32 v143, v143
  v_pk_mul_f32 v[136:137], v[136:137], v[48:49]
  v_pk_mul_f32 v[138:139], v[138:139], v[50:51]
  v_pk_mul_f32 v[140:141], v[140:141], v[52:53]
  v_pk_mul_f32 v[142:143], v[142:143], v[54:55]
  v_cvt_pk_bf16_f32 v148, v136, v137
  v_cvt_pk_bf16_f32 v149, v138, v139
  v_cvt_pk_bf16_f32 v150, v140, v141
  v_cvt_pk_bf16_f32 v151, v142, v143
  buffer_store_dwordx4 v[148:151], v238, s[32:35], 0 offen offset:1024 sc1
  s_add_u32 m0, s57, 8192
  s_lshl4_add_u32 s53, s75, 32768
  buffer_load_dwordx4 v2, s[24:27], s53 offen offset:0 lds
  buffer_load_dwordx4 v3, s[24:27], s53 offen offset:1024 lds
  buffer_load_dwordx4 v4, s[24:27], s53 offen offset:2048 lds
  buffer_load_dwordx4 v5, s[24:27], s53 offen offset:3072 lds
  v_pk_fma_f32 v[40:41], v[96:97], v[16:17], v[40:41] op_sel_hi:[1,0,1]
  v_pk_fma_f32 v[42:43], v[98:99], v[16:17], v[42:43] op_sel_hi:[1,0,1]
  v_pk_fma_f32 v[44:45], v[100:101], v[16:17], v[44:45] op_sel_hi:[1,0,1]
  v_pk_fma_f32 v[46:47], v[102:103], v[16:17], v[46:47] op_sel_hi:[1,0,1]
  v_pk_mul_f32 v[128:129], v[40:41], v[40:41]
  v_pk_mul_f32 v[130:131], v[42:43], v[42:43]
  v_pk_mul_f32 v[132:133], v[44:45], v[44:45]
  v_pk_mul_f32 v[134:135], v[46:47], v[46:47]
  v_pk_fma_f32 v[128:129], v[128:129], v[24:25], v[24:25] op_sel:[0,0,1] op_sel_hi:[1,0,1]
  v_pk_fma_f32 v[130:131], v[130:131], v[24:25], v[24:25] op_sel:[0,0,1] op_sel_hi:[1,0,1]
  v_pk_fma_f32 v[132:133], v[132:133], v[24:25], v[24:25] op_sel:[0,0,1] op_sel_hi:[1,0,1]
  v_pk_fma_f32 v[134:135], v[134:135], v[24:25], v[24:25] op_sel:[0,0,1] op_sel_hi:[1,0,1]
  v_pk_mul_f32 v[128:129], v[128:129], v[40:41]
  v_exp_f32 v128, v128
  v_exp_f32 v129, v129
  v_pk_mul_f32 v[130:131], v[130:131], v[42:43]
  v_exp_f32 v130, v130
  v_exp_f32 v131, v131
  v_pk_mul_f32 v[132:133], v[132:133], v[44:45]
  v_exp_f32 v132, v132
  v_exp_f32 v133, v133
  v_pk_mul_f32 v[134:135], v[134:135], v[46:47]
  v_exp_f32 v134, v134
  v_exp_f32 v135, v135
  v_pk_fma_f32 v[128:129], v[128:129], v[16:17], v[16:17] op_sel:[0,1,1] op_sel_hi:[1,1,1]
  v_rcp_f32 v128, v128
  v_rcp_f32 v129, v129
  v_pk_fma_f32 v[130:131], v[130:131], v[16:17], v[16:17] op_sel:[0,1,1] op_sel_hi:[1,1,1]
  v_rcp_f32 v130, v130
  v_rcp_f32 v131, v131
  v_pk_fma_f32 v[132:133], v[132:133], v[16:17], v[16:17] op_sel:[0,1,1] op_sel_hi:[1,1,1]
  v_rcp_f32 v132, v132
  v_rcp_f32 v133, v133
  v_pk_fma_f32 v[134:135], v[134:135], v[16:17], v[16:17] op_sel:[0,1,1] op_sel_hi:[1,1,1]
  v_rcp_f32 v134, v134
  v_rcp_f32 v135, v135
  v_pk_mul_f32 v[128:129], v[128:129], v[40:41]
  v_pk_mul_f32 v[130:131], v[130:131], v[42:43]
  v_pk_mul_f32 v[132:133], v[132:133], v[44:45]
  v_pk_mul_f32 v[134:135], v[134:135], v[46:47]
  v_cvt_pk_bf16_f32 v144, v128, v129
  v_cvt_pk_bf16_f32 v145, v130, v131
  v_cvt_pk_bf16_f32 v146, v132, v133
  v_cvt_pk_bf16_f32 v147, v134, v135
  buffer_store_dwordx4 v[144:147], v238, s[32:35], 0 offen offset:2048 sc1
  v_pk_fma_f32 v[56:57], v[96:97], v[26:27], v[56:57] op_sel_hi:[1,0,1]
  v_pk_fma_f32 v[58:59], v[98:99], v[26:27], v[58:59] op_sel_hi:[1,0,1]
  v_pk_fma_f32 v[60:61], v[100:101], v[26:27], v[60:61] op_sel_hi:[1,0,1]
  v_pk_fma_f32 v[62:63], v[102:103], v[26:27], v[62:63] op_sel_hi:[1,0,1]
  v_pk_mul_f32 v[136:137], v[56:57], v[56:57]
  v_pk_mul_f32 v[138:139], v[58:59], v[58:59]
  v_pk_mul_f32 v[140:141], v[60:61], v[60:61]
  v_pk_mul_f32 v[142:143], v[62:63], v[62:63]
  v_pk_fma_f32 v[136:137], v[136:137], v[28:29], v[28:29] op_sel:[0,0,1] op_sel_hi:[1,0,1]
  v_pk_fma_f32 v[138:139], v[138:139], v[28:29], v[28:29] op_sel:[0,0,1] op_sel_hi:[1,0,1]
  v_pk_fma_f32 v[140:141], v[140:141], v[28:29], v[28:29] op_sel:[0,0,1] op_sel_hi:[1,0,1]
  v_pk_fma_f32 v[142:143], v[142:143], v[28:29], v[28:29] op_sel:[0,0,1] op_sel_hi:[1,0,1]
  v_pk_mul_f32 v[136:137], v[136:137], v[56:57]
  v_exp_f32 v136, v136
  v_exp_f32 v137, v137
  v_pk_mul_f32 v[138:139], v[138:139], v[58:59]
  v_exp_f32 v138, v138
  v_exp_f32 v139, v139
  v_pk_mul_f32 v[140:141], v[140:141], v[60:61]
  v_exp_f32 v140, v140
  v_exp_f32 v141, v141
  v_pk_mul_f32 v[142:143], v[142:143], v[62:63]
  v_exp_f32 v142, v142
  v_exp_f32 v143, v143
  v_pk_fma_f32 v[136:137], v[136:137], v[26:27], v[26:27] op_sel:[0,1,1] op_sel_hi:[1,1,1]
  v_rcp_f32_e64 v136, v136
  ds_read_b64_tr_b16 v[160:161], v232 offset:0
  ds_read_b64_tr_b16 v[162:163], v232 offset:1536
  ds_read_b64_tr_b16 v[164:165], v232 offset:32
  ds_read_b64_tr_b16 v[166:167], v232 offset:1568
  ds_read_b64_tr_b16 v[168:169], v232 offset:64
  ds_read_b64_tr_b16 v[170:171], v232 offset:1600
  v_rcp_f32 v137, v137
  v_pk_fma_f32 v[138:139], v[138:139], v[26:27], v[26:27] op_sel:[0,1,1] op_sel_hi:[1,1,1]
  v_rcp_f32 v138, v138
  v_rcp_f32 v139, v139
  v_pk_fma_f32 v[140:141], v[140:141], v[26:27], v[26:27] op_sel:[0,1,1] op_sel_hi:[1,1,1]
  v_rcp_f32 v140, v140
  v_rcp_f32_e64 v141, v141
  ds_read_b64_tr_b16 v[176:177], v232 offset:3072
  ds_read_b64_tr_b16 v[178:179], v232 offset:4608
  ds_read_b64_tr_b16 v[180:181], v232 offset:3104
  ds_read_b64_tr_b16 v[182:183], v232 offset:4640
  ds_read_b64_tr_b16 v[184:185], v232 offset:3136
  ds_read_b64_tr_b16 v[186:187], v232 offset:4672
  v_pk_fma_f32 v[142:143], v[142:143], v[26:27], v[26:27] op_sel:[0,1,1] op_sel_hi:[1,1,1]
  v_rcp_f32 v142, v142
  v_rcp_f32 v143, v143
  v_pk_mul_f32 v[136:137], v[136:137], v[56:57]
  v_pk_mul_f32 v[138:139], v[138:139], v[58:59]
  v_pk_mul_f32 v[140:141], v[140:141], v[60:61]
  v_pk_mul_f32 v[142:143], v[142:143], v[62:63]
  v_cvt_pk_bf16_f32 v148, v136, v137
  v_cvt_pk_bf16_f32 v149, v138, v139
  v_cvt_pk_bf16_f32 v150, v140, v141
  v_cvt_pk_bf16_f32 v151, v142, v143
  buffer_store_dwordx4 v[148:151], v238, s[32:35], 0 offen offset:3072 sc1
  buffer_load_dword v7, v218, s[32:35], 0 offen sc1
  s_waitcnt lgkmcnt(6)
  v_mfma_f32_16x16x32_bf16 v[64:67], v[160:163], a[0:3], v[64:67]
  ds_read_b64_tr_b16 v[192:193], v232 offset:6144
  s_add_u32 m0, s57, 12288
  v_mfma_f32_16x16x32_bf16 v[76:79], v[160:163], a[4:7], v[76:79]
  ds_read_b64_tr_b16 v[194:195], v232 offset:7680
  s_lshl4_add_u32 s53, s76, 0
  v_mfma_f32_16x16x32_bf16 v[68:71], v[164:167], a[0:3], v[68:71]
  ds_read_b64_tr_b16 v[196:197], v232 offset:6176
  buffer_load_dwordx4 v248, s[24:27], s53 offen offset:0 lds
  v_mfma_f32_16x16x32_bf16 v[80:83], v[164:167], a[4:7], v[80:83]
  ds_read_b64_tr_b16 v[198:199], v232 offset:7712
  s_waitcnt vmcnt(18)
  v_mfma_f32_16x16x32_bf16 v[72:75], v[168:171], a[0:3], v[72:75]
  ds_read_b64_tr_b16 v[200:201], v232 offset:6208
  ds_read_b64_tr_b16 a[162:163], v240 offset:0
  v_mfma_f32_16x16x32_bf16 v[84:87], v[168:171], a[4:7], v[84:87]
  ds_read_b64_tr_b16 v[202:203], v232 offset:7744
  s_waitcnt lgkmcnt(7)
  v_mfma_f32_16x16x32_bf16 v[64:67], v[176:179], a[8:11], v[64:67]
  ds_read_b64_tr_b16 v[160:161], v232 offset:9216
  buffer_load_dwordx4 v249, s[24:27], s53 offen offset:1024 lds
  v_mfma_f32_16x16x32_bf16 v[76:79], v[176:179], a[12:15], v[76:79]
  ds_read_b64_tr_b16 v[162:163], v232 offset:10752
  ds_read_b64_tr_b16 a[166:167], v241 offset:0
  v_mfma_f32_16x16x32_bf16 v[68:71], v[180:183], a[8:11], v[68:71]
  ds_read_b64_tr_b16 v[164:165], v232 offset:9248
  ds_read_b64_tr_b16 a[170:171], v242 offset:0
  v_mfma_f32_16x16x32_bf16 v[80:83], v[180:183], a[12:15], v[80:83]
  ds_read_b64_tr_b16 v[166:167], v232 offset:10784
  buffer_load_dwordx4 v250, s[24:27], s53 offen offset:2048 lds
  v_mfma_f32_16x16x32_bf16 v[72:75], v[184:187], a[8:11], v[72:75]
  ds_read_b64_tr_b16 v[168:169], v232 offset:9280
  ds_read_b64_tr_b16 a[174:175], v243 offset:0
  v_mfma_f32_16x16x32_bf16 v[84:87], v[184:187], a[12:15], v[84:87]
  ds_read_b64_tr_b16 v[170:171], v232 offset:10816
  s_waitcnt lgkmcnt(9)
  v_mfma_f32_16x16x32_bf16 v[64:67], v[192:195], a[16:19], v[64:67]
  ds_read_b64_tr_b16 v[176:177], v232 offset:12288
  buffer_load_dwordx4 v251, s[24:27], s53 offen offset:3072 lds
  v_mfma_f32_16x16x32_bf16 v[76:79], v[192:195], a[20:23], v[76:79]
  ds_read_b64_tr_b16 v[178:179], v232 offset:13824
  s_add_u32 m0, s58, 0
  v_mfma_f32_16x16x32_bf16 v[68:71], v[196:199], a[16:19], v[68:71]
  ds_read_b64_tr_b16 v[180:181], v232 offset:12320
  s_lshl4_add_u32 s53, s76, 32768
  v_mfma_f32_16x16x32_bf16 v[80:83], v[196:199], a[20:23], v[80:83]
  ds_read_b64_tr_b16 v[182:183], v232 offset:13856
  ds_read_b64_tr_b16 a[176:177], v240 offset:2048
  v_mfma_f32_16x16x32_bf16 v[72:75], v[200:203], a[16:19], v[72:75]
  ds_read_b64_tr_b16 v[184:185], v232 offset:12352
  ds_read_b64_tr_b16 a[180:181], v241 offset:2048
  v_mfma_f32_16x16x32_bf16 v[84:87], v[200:203], a[20:23], v[84:87]
  ds_read_b64_tr_b16 v[186:187], v232 offset:13888
  s_waitcnt lgkmcnt(8)
  v_mfma_f32_16x16x32_bf16 v[64:67], v[160:163], a[24:27], v[64:67]
  ds_read_b64_tr_b16 v[192:193], v232 offset:15360
  ds_read_b64_tr_b16 a[184:185], v242 offset:2048
  v_mfma_f32_16x16x32_bf16 v[76:79], v[160:163], a[28:31], v[76:79]
  ds_read_b64_tr_b16 v[194:195], v232 offset:16896
  ds_read_b64_tr_b16 a[188:189], v243 offset:2048
  v_mfma_f32_16x16x32_bf16 v[68:71], v[164:167], a[24:27], v[68:71]
  ds_read_b64_tr_b16 v[196:197], v232 offset:15392
  ds_read_b64_tr_b16 a[178:179], v240 offset:4096
  v_mfma_f32_16x16x32_bf16 v[80:83], v[164:167], a[28:31], v[80:83]
  ds_read_b64_tr_b16 v[198:199], v232 offset:16928
  ds_read_b64_tr_b16 a[182:183], v241 offset:4096
  v_mfma_f32_16x16x32_bf16 v[72:75], v[168:171], a[24:27], v[72:75]
  ds_read_b64_tr_b16 v[200:201], v232 offset:15424
  ds_read_b64_tr_b16 a[186:187], v242 offset:4096
  v_mfma_f32_16x16x32_bf16 v[84:87], v[168:171], a[28:31], v[84:87]
  ds_read_b64_tr_b16 v[202:203], v232 offset:16960
  s_waitcnt lgkmcnt(11)
  v_mfma_f32_16x16x32_bf16 v[64:67], v[176:179], a[32:35], v[64:67]
  ds_read_b64_tr_b16 v[160:161], v232 offset:18432
  buffer_load_dwordx4 v248, s[24:27], s53 offen offset:0 lds
  v_mfma_f32_16x16x32_bf16 v[76:79], v[176:179], a[36:39], v[76:79]
  ds_read_b64_tr_b16 v[162:163], v232 offset:19968
  ds_read_b64_tr_b16 a[190:191], v243 offset:4096
  v_mfma_f32_16x16x32_bf16 v[68:71], v[180:183], a[32:35], v[68:71]
  ds_read_b64_tr_b16 v[164:165], v232 offset:18464
  ds_read_b64_tr_b16 a[192:193], v240 offset:6144
  v_mfma_f32_16x16x32_bf16 v[80:83], v[180:183], a[36:39], v[80:83]
  ds_read_b64_tr_b16 v[166:167], v232 offset:20000
  buffer_load_dwordx4 v249, s[24:27], s53 offen offset:1024 lds
  v_mfma_f32_16x16x32_bf16 v[72:75], v[184:187], a[32:35], v[72:75]
  ds_read_b64_tr_b16 v[168:169], v232 offset:18496
  ds_read_b64_tr_b16 a[196:197], v241 offset:6144
  v_mfma_f32_16x16x32_bf16 v[84:87], v[184:187], a[36:39], v[84:87]
  ds_read_b64_tr_b16 v[170:171], v232 offset:20032
  s_waitcnt lgkmcnt(9)
  v_mfma_f32_16x16x32_bf16 v[64:67], v[192:195], a[40:43], v[64:67]
  ds_read_b64_tr_b16 v[176:177], v232 offset:21504
  ds_read_b64_tr_b16 a[200:201], v242 offset:6144
  v_mfma_f32_16x16x32_bf16 v[76:79], v[192:195], a[44:47], v[76:79]
  ds_read_b64_tr_b16 v[178:179], v232 offset:23040
  ds_read_b64_tr_b16 a[204:205], v243 offset:6144
  v_mfma_f32_16x16x32_bf16 v[68:71], v[196:199], a[40:43], v[68:71]
  ds_read_b64_tr_b16 v[180:181], v232 offset:21536
  buffer_load_dwordx4 v250, s[24:27], s53 offen offset:2048 lds
  v_mfma_f32_16x16x32_bf16 v[80:83], v[196:199], a[44:47], v[80:83]
  ds_read_b64_tr_b16 v[182:183], v232 offset:23072
  ds_read_b64_tr_b16 a[194:195], v240 offset:8192
  v_mfma_f32_16x16x32_bf16 v[72:75], v[200:203], a[40:43], v[72:75]
  ds_read_b64_tr_b16 v[184:185], v232 offset:21568
  ds_read_b64_tr_b16 a[198:199], v241 offset:8192
  v_mfma_f32_16x16x32_bf16 v[84:87], v[200:203], a[44:47], v[84:87]
  ds_read_b64_tr_b16 v[186:187], v232 offset:23104
  s_waitcnt lgkmcnt(10)
  v_mfma_f32_16x16x32_bf16 v[64:67], v[160:163], a[48:51], v[64:67]
  ds_read_b64_tr_b16 v[192:193], v232 offset:24576
  buffer_load_dwordx4 v251, s[24:27], s53 offen offset:3072 lds
  v_mfma_f32_16x16x32_bf16 v[76:79], v[160:163], a[52:55], v[76:79]
  ds_read_b64_tr_b16 v[194:195], v232 offset:26112
  s_add_u32 m0, s58, 4096
  v_mfma_f32_16x16x32_bf16 v[68:71], v[164:167], a[48:51], v[68:71]
  ds_read_b64_tr_b16 v[196:197], v232 offset:24608
  s_lshl4_add_u32 s53, s77, 16384
  v_mfma_f32_16x16x32_bf16 v[80:83], v[164:167], a[52:55], v[80:83]
  ds_read_b64_tr_b16 v[198:199], v232 offset:26144
  buffer_load_dwordx4 v248, s[24:27], s53 offen offset:0 lds
  v_mfma_f32_16x16x32_bf16 v[72:75], v[168:171], a[48:51], v[72:75]
  ds_read_b64_tr_b16 v[200:201], v232 offset:24640
  ds_read_b64_tr_b16 a[202:203], v242 offset:8192
  v_mfma_f32_16x16x32_bf16 v[84:87], v[168:171], a[52:55], v[84:87]
  ds_read_b64_tr_b16 v[202:203], v232 offset:26176
  s_waitcnt lgkmcnt(7)
  v_mfma_f32_16x16x32_bf16 v[64:67], v[176:179], a[56:59], v[64:67]
  ds_read_b64_tr_b16 v[160:161], v232 offset:27648
  buffer_load_dwordx4 v249, s[24:27], s53 offen offset:1024 lds
  v_mfma_f32_16x16x32_bf16 v[76:79], v[176:179], a[60:63], v[76:79]
  ds_read_b64_tr_b16 v[162:163], v232 offset:29184
  ds_read_b64_tr_b16 a[206:207], v243 offset:8192
  v_mfma_f32_16x16x32_bf16 v[68:71], v[180:183], a[56:59], v[68:71]
  ds_read_b64_tr_b16 v[164:165], v232 offset:27680
  s_waitcnt vmcnt(23)
  v_mfma_f32_16x16x32_bf16 v[80:83], v[180:183], a[60:63], v[80:83]
  ds_read_b64_tr_b16 v[166:167], v232 offset:29216
  buffer_load_dwordx4 v250, s[24:27], s53 offen offset:2048 lds
  v_mfma_f32_16x16x32_bf16 v[72:75], v[184:187], a[56:59], v[72:75]
  ds_read_b64_tr_b16 v[168:169], v232 offset:27712
  ds_read_b64_tr_b16 a[208:209], v244 offset:0
  v_mfma_f32_16x16x32_bf16 v[84:87], v[184:187], a[60:63], v[84:87]
  ds_read_b64_tr_b16 v[170:171], v232 offset:29248
  s_waitcnt lgkmcnt(8)
  v_mfma_f32_16x16x32_bf16 v[64:67], v[192:195], a[64:67], v[64:67]
  ds_read_b64_tr_b16 v[176:177], v232 offset:30720
  buffer_load_dwordx4 v251, s[24:27], s53 offen offset:3072 lds
  v_mfma_f32_16x16x32_bf16 v[76:79], v[192:195], a[68:71], v[76:79]
  ds_read_b64_tr_b16 v[178:179], v232 offset:32256
  s_add_u32 m0, s58, 8192
  v_mfma_f32_16x16x32_bf16 v[68:71], v[196:199], a[64:67], v[68:71]
  ds_read_b64_tr_b16 v[180:181], v232 offset:30752
  s_lshl4_add_u32 s53, s78, 0
  v_mfma_f32_16x16x32_bf16 v[80:83], v[196:199], a[68:71], v[80:83]
  ds_read_b64_tr_b16 v[182:183], v232 offset:32288
  ds_read_b64_tr_b16 a[212:213], v245 offset:0
  v_mfma_f32_16x16x32_bf16 v[72:75], v[200:203], a[64:67], v[72:75]
  ds_read_b64_tr_b16 v[184:185], v232 offset:30784
  ds_read_b64_tr_b16 a[216:217], v246 offset:0
  v_mfma_f32_16x16x32_bf16 v[84:87], v[200:203], a[68:71], v[84:87]
  ds_read_b64_tr_b16 v[186:187], v232 offset:32320
  s_waitcnt lgkmcnt(8)
  v_mfma_f32_16x16x32_bf16 v[64:67], v[160:163], a[72:75], v[64:67]
  ds_read_b64_tr_b16 v[192:193], v232 offset:33792
  ds_read_b64_tr_b16 a[220:221], v247 offset:0
  s_waitcnt vmcnt(12)
  v_cmp_ne_u32 vcc, v7, v6
  s_nop 0
  s_cbranch_vccz L_spin3_done
L_spin3:
  buffer_load_dword v7, v218, s[32:35], 0 offen sc1
  s_waitcnt vmcnt(0)
  v_cmp_ne_u32 vcc, v7, v6
  s_sub_u32 s46, s46, 1
  s_cmp_lt_i32 s46, 0
  s_cbranch_scc1 L_spin3_done
  s_cbranch_vccnz L_spin3
L_spin3_done:
  s_barrier
  buffer_store_dword v6, v1, s[32:35], s55 offen sc1
  s_add_u32 s55, s55, 16
  v_mfma_f32_16x16x32_bf16 v[76:79], v[160:163], a[76:79], v[76:79]
  ds_read_b64_tr_b16 v[194:195], v232 offset:35328
  ds_read_b64_tr_b16 a[210:211], v244 offset:2048
  v_mfma_f32_16x16x32_bf16 v[68:71], v[164:167], a[72:75], v[68:71]
  ds_read_b64_tr_b16 v[196:197], v232 offset:33824
  buffer_load_dwordx4 v248, s[24:27], s53 offen offset:0 lds
  v_mfma_f32_16x16x32_bf16 v[80:83], v[164:167], a[76:79], v[80:83]
  ds_read_b64_tr_b16 v[198:199], v232 offset:35360
  ds_read_b64_tr_b16 a[214:215], v245 offset:2048
  v_mfma_f32_16x16x32_bf16 v[72:75], v[168:171], a[72:75], v[72:75]
  ds_read_b64_tr_b16 v[200:201], v232 offset:33856
  ds_read_b64_tr_b16 a[218:219], v246 offset:2048
  v_mfma_f32_16x16x32_bf16 v[84:87], v[168:171], a[76:79], v[84:87]
  ds_read_b64_tr_b16 v[202:203], v232 offset:35392
  s_waitcnt lgkmcnt(10)
  v_mfma_f32_16x16x32_bf16 v[64:67], v[176:179], a[80:83], v[64:67]
  ds_read_b64_tr_b16 v[160:161], v232 offset:36864
  buffer_load_dwordx4 v249, s[24:27], s53 offen offset:1024 lds
  v_mfma_f32_16x16x32_bf16 v[76:79], v[176:179], a[84:87], v[76:79]
  ds_read_b64_tr_b16 v[162:163], v232 offset:38400
  s_add_u32 m0, s57, 0
  v_mfma_f32_16x16x32_bf16 v[68:71], v[180:183], a[80:83], v[68:71]
  ds_read_b64_tr_b16 v[164:165], v232 offset:36896
  s_lshl4_add_u32 s53, s78, 16384
L_pad5:
  s_cbranch_execz L_hopA
  v_mfma_f32_16x16x32_bf16 v[80:83], v[180:183], a[84:87], v[80:83]
  ds_read_b64_tr_b16 v[166:167], v232 offset:38432
  ds_read_b64_tr_b16 a[222:223], v247 offset:2048
  v_mfma_f32_16x16x32_bf16 v[72:75], v[184:187], a[80:83], v[72:75]
  ds_read_b64_tr_b16 v[168:169], v232 offset:36928
  v_mfma_f32_16x16x32_bf16 v[84:87], v[184:187], a[84:87], v[84:87]
  ds_read_b64_tr_b16 v[170:171], v232 offset:38464
  s_waitcnt lgkmcnt(7)
  v_mfma_f32_16x16x32_bf16 v[64:67], v[192:195], a[88:91], v[64:67]
  ds_read_b64_tr_b16 v[176:177], v232 offset:39936
  ds_read_b64_tr_b16 a[224:225], v244 offset:4096
  v_mfma_f32_16x16x32_bf16 v[76:79], v[192:195], a[92:95], v[76:79]
  ds_read_b64_tr_b16 v[178:179], v232 offset:41472
  buffer_load_dwordx4 v248, s[24:27], s53 offen offset:0 lds
  v_mfma_f32_16x16x32_bf16 v[68:71], v[196:199], a[88:91], v[68:71]
  ds_read_b64_tr_b16 v[180:181], v232 offset:39968
  ds_read_b64_tr_b16 a[228:229], v245 offset:4096
  v_mfma_f32_16x16x32_bf16 v[80:83], v[196:199], a[92:95], v[80:83]
  ds_read_b64_tr_b16 v[182:183], v232 offset:41504
  ds_read_b64_tr_b16 a[232:233], v246 offset:4096
  v_mfma_f32_16x16x32_bf16 v[72:75], v[200:203], a[88:91], v[72:75]
  ds_read_b64_tr_b16 v[184:185], v232 offset:40000
  buffer_load_dwordx4 v249, s[24:27], s53 offen offset:1024 lds
  v_mfma_f32_16x16x32_bf16 v[84:87], v[200:203], a[92:95], v[84:87]
  ds_read_b64_tr_b16 v[186:187], v232 offset:41536
  s_waitcnt lgkmcnt(9)
  v_mfma_f32_16x16x32_bf16 v[64:67], v[160:163], a[96:99], v[64:67]
  ds_read_b64_tr_b16 v[192:193], v232 offset:43008
  ds_read_b64_tr_b16 a[236:237], v247 offset:4096
  v_mfma_f32_16x16x32_bf16 v[76:79], v[160:163], a[100:103], v[76:79]
  ds_read_b64_tr_b16 v[194:195], v232 offset:44544
  ds_read_b64_tr_b16 a[226:227], v244 offset:6144
  v_mfma_f32_16x16x32_bf16 v[68:71], v[164:167], a[96:99], v[68:71]
  ds_read_b64_tr_b16 v[196:197], v232 offset:43040
  ds_read_b64_tr_b16 a[230:231], v245 offset:6144
  v_mfma_f32_16x16x32_bf16 v[80:83], v[164:167], a[100:103], v[80:83]
  ds_read_b64_tr_b16 v[198:199], v232 offset:44576
  ds_read_b64_tr_b16 a[234:235], v246 offset:6144
  v_mfma_f32_16x16x32_bf16 v[72:75], v[168:171], a[96:99], v[72:75]
  ds_read_b64_tr_b16 v[200:201], v232 offset:43072
  buffer_load_dwordx4 v250, s[24:27], s53 offen offset:2048 lds
  v_mfma_f32_16x16x32_bf16 v[84:87], v[168:171], a[100:103], v[84:87]
  ds_read_b64_tr_b16 v[202:203], v232 offset:44608
  s_waitcnt lgkmcnt(10)
  v_mfma_f32_16x16x32_bf16 v[64:67], v[176:179], a[104:107], v[64:67]
  ds_read_b64_tr_b16 v[160:161], v232 offset:46080
  ds_read_b64_tr_b16 a[238:239], v247 offset:6144
  v_mfma_f32_16x16x32_bf16 v[76:79], v[176:179], a[108:111], v[76:79]
  ds_read_b64_tr_b16 v[162:163], v232 offset:47616
  buffer_load_dwordx4 v251, s[24:27], s53 offen offset:3072 lds
  v_mfma_f32_16x16x32_bf16 v[68:71], v[180:183], a[104:107], v[68:71]
  ds_read_b64_tr_b16 v[164:165], v232 offset:46112
  s_add_u32 m0, s57, 4096
  v_mfma_f32_16x16x32_bf16 v[80:83], v[180:183], a[108:111], v[80:83]
  ds_read_b64_tr_b16 v[166:167], v232 offset:47648
  s_lshl4_add_u32 s53, s79, 32768
  v_mfma_f32_16x16x32_bf16 v[72:75], v[184:187], a[104:107], v[72:75]
  ds_read_b64_tr_b16 v[168:169], v232 offset:46144
  v_mfma_f32_16x16x32_bf16 v[84:87], v[184:187], a[108:111], v[84:87]
  ds_read_b64_tr_b16 v[170:171], v232 offset:47680
  s_waitcnt lgkmcnt(7)
  v_mfma_f32_16x16x32_bf16 v[64:67], v[192:195], a[112:115], v[64:67]
  ds_read_b64_tr_b16 a[240:241], v244 offset:8192
  ds_read_b64_tr_b16 a[244:245], v245 offset:8192
  v_mfma_f32_16x16x32_bf16 v[76:79], v[192:195], a[116:119], v[76:79]
  buffer_load_dwordx4 v248, s[24:27], s53 offen offset:0 lds
  ds_read_b64_tr_b16 a[248:249], v246 offset:8192
  v_mfma_f32_16x16x32_bf16 v[68:71], v[196:199], a[112:115], v[68:71]
  ds_read_b64_tr_b16 a[252:253], v247 offset:8192
  ds_read_b64_tr_b16 a[242:243], v244 offset:10240
  v_mfma_f32_16x16x32_bf16 v[80:83], v[196:199], a[116:119], v[80:83]
  ds_read_b64_tr_b16 a[246:247], v245 offset:10240
  ds_read_b64_tr_b16 a[250:251], v246 offset:10240
  v_mfma_f32_16x16x32_bf16 v[72:75], v[200:203], a[112:115], v[72:75]
  buffer_load_dwordx4 v249, s[24:27], s53 offen offset:1024 lds
  s_add_u32 m0, s57, 6144
  v_mfma_f32_16x16x32_bf16 v[84:87], v[200:203], a[116:119], v[84:87]
  s_lshl4_add_u32 s53, s79, 0
  s_waitcnt lgkmcnt(7)
  v_mfma_f32_16x16x32_bf16 v[64:67], v[160:163], a[120:123], v[64:67]
  ds_read_b64_tr_b16 a[254:255], v247 offset:10240
  v_mfma_f32_16x16x32_bf16 v[76:79], v[160:163], a[124:127], v[76:79]
  buffer_load_dwordx4 v248, s[24:27], s53 offen offset:0 lds
  v_mfma_f32_16x16x32_bf16 v[68:71], v[164:167], a[120:123], v[68:71]
  v_mfma_f32_16x16x32_bf16 v[80:83], v[164:167], a[124:127], v[80:83]
  v_mfma_f32_16x16x32_bf16 v[72:75], v[168:171], a[120:123], v[72:75]
  buffer_load_dwordx4 v249, s[24:27], s53 offen offset:1024 lds
  v_mfma_f32_16x16x32_bf16 v[84:87], v[168:171], a[124:127], v[84:87]
  buffer_load_dword a96, v223, s[32:35], 0 offen offset:0 sc1
  buffer_load_dword a97, v223, s[32:35], 0 offen offset:128 sc1
  buffer_load_dword a98, v223, s[32:35], 0 offen offset:256 sc1
  v_pk_mul_f32 v[192:193], v[64:65], v[64:65]
  v_pk_mul_f32 v[194:195], v[66:67], v[66:67]
  v_pk_mul_f32 v[196:197], v[68:69], v[68:69]
  v_pk_mul_f32 v[198:199], v[70:71], v[70:71]
  v_pk_fma_f32 v[192:193], v[192:193], v[24:25], v[24:25] op_sel:[0,0,1] op_sel_hi:[1,0,1]
  v_pk_fma_f32 v[194:195], v[194:195], v[24:25], v[24:25] op_sel:[0,0,1] op_sel_hi:[1,0,1]
  v_pk_fma_f32 v[196:197], v[196:197], v[24:25], v[24:25] op_sel:[0,0,1] op_sel_hi:[1,0,1]
  v_pk_fma_f32 v[198:199], v[198:199], v[24:25], v[24:25] op_sel:[0,0,1] op_sel_hi:[1,0,1]
  v_pk_mul_f32 v[192:193], v[192:193], v[64:65]
  v_exp_f32 v192, v192
  v_exp_f32 v193, v193
  v_pk_mul_f32 v[194:195], v[194:195], v[66:67]
  v_exp_f32 v194, v194
  v_exp_f32 v195, v195
  v_pk_mul_f32 v[196:197], v[196:197], v[68:69]
  v_exp_f32 v196, v196
  v_exp_f32 v197, v197
  v_pk_mul_f32 v[198:199], v[198:199], v[70:71]
  v_exp_f32 v198, v198
  v_exp_f32 v199, v199
  buffer_load_dword a99, v223, s[32:35], 0 offen offset:384 sc1
  buffer_load_dword a100, v223, s[32:35], 0 offen offset:1024 sc1
  buffer_load_dword a101, v223, s[32:35], 0 offen offset:1152 sc1
  v_pk_fma_f32 v[192:193], v[192:193], v[16:17], v[16:17] op_sel:[0,1,1] op_sel_hi:[1,1,1]
  v_rcp_f32 v192, v192
  v_rcp_f32 v193, v193
  v_pk_fma_f32 v[194:195], v[194:195], v[16:17], v[16:17] op_sel:[0,1,1] op_sel_hi:[1,1,1]
  v_rcp_f32 v194, v194
  v_rcp_f32 v195, v195
  v_pk_fma_f32 v[196:197], v[196:197], v[16:17], v[16:17] op_sel:[0,1,1] op_sel_hi:[1,1,1]
  v_rcp_f32 v196, v196
  v_rcp_f32 v197, v197
  v_pk_fma_f32 v[198:199], v[198:199], v[16:17], v[16:17] op_sel:[0,1,1] op_sel_hi:[1,1,1]
  v_rcp_f32 v198, v198
  v_rcp_f32 v199, v199
  v_pk_mul_f32 v[192:193], v[192:193], v[64:65]
  v_pk_mul_f32 v[194:195], v[194:195], v[66:67]
  v_pk_mul_f32 v[196:197], v[196:197], v[68:69]
  v_pk_mul_f32 v[198:199], v[198:199], v[70:71]
  v_cvt_pk_bf16_f32 v208, v192, v193
  v_cvt_pk_bf16_f32 v209, v194, v195
  v_cvt_pk_bf16_f32 v210, v196, v197
  v_cvt_pk_bf16_f32 v211, v198, v199
  buffer_store_dwordx4 v[208:211], v239, s[32:35], 0 offen offset:0 sc1
  s_load_dwordx4 s[8:11], s[32:33], s59 glc
  buffer_load_dword a102, v223, s[32:35], 0 offen offset:1280 sc1
  buffer_load_dword a103, v223, s[32:35], 0 offen offset:1408 sc1
  buffer_load_dword a104, v223, s[32:35], 0 offen offset:2048 sc1
  v_pk_mul_f32 v[200:201], v[76:77], v[76:77]
  v_pk_mul_f32 v[202:203], v[78:79], v[78:79]
  v_pk_mul_f32 v[204:205], v[80:81], v[80:81]
  v_pk_mul_f32 v[206:207], v[82:83], v[82:83]
  v_pk_fma_f32 v[200:201], v[200:201], v[28:29], v[28:29] op_sel:[0,0,1] op_sel_hi:[1,0,1]
  v_pk_fma_f32 v[202:203], v[202:203], v[28:29], v[28:29] op_sel:[0,0,1] op_sel_hi:[1,0,1]
  v_pk_fma_f32 v[204:205], v[204:205], v[28:29], v[28:29] op_sel:[0,0,1] op_sel_hi:[1,0,1]
  v_pk_fma_f32 v[206:207], v[206:207], v[28:29], v[28:29] op_sel:[0,0,1] op_sel_hi:[1,0,1]
  v_pk_mul_f32 v[200:201], v[200:201], v[76:77]
  v_exp_f32 v200, v200
  v_exp_f32 v201, v201
  v_pk_mul_f32 v[202:203], v[202:203], v[78:79]
  v_exp_f32 v202, v202
  v_exp_f32 v203, v203
  v_pk_mul_f32 v[204:205], v[204:205], v[80:81]
  v_exp_f32 v204, v204
  v_exp_f32 v205, v205
  v_pk_mul_f32 v[206:207], v[206:207], v[82:83]
  v_exp_f32 v206, v206
  v_exp_f32 v207, v207
  buffer_load_dword a105, v223, s[32:35], 0 offen offset:2176 sc1
  buffer_load_dword a106, v223, s[32:35], 0 offen offset:2304 sc1
  buffer_load_dword a107, v223, s[32:35], 0 offen offset:2432 sc1
  v_pk_fma_f32 v[200:201], v[200:201], v[26:27], v[26:27] op_sel:[0,1,1] op_sel_hi:[1,1,1]
  v_rcp_f32 v200, v200
  v_rcp_f32 v201, v201
  v_pk_fma_f32 v[202:203], v[202:203], v[26:27], v[26:27] op_sel:[0,1,1] op_sel_hi:[1,1,1]
  v_rcp_f32 v202, v202
  v_rcp_f32 v203, v203
  v_pk_fma_f32 v[204:205], v[204:205], v[26:27], v[26:27] op_sel:[0,1,1] op_sel_hi:[1,1,1]
  v_rcp_f32 v204, v204
  v_rcp_f32 v205, v205
  v_pk_fma_f32 v[206:207], v[206:207], v[26:27], v[26:27] op_sel:[0,1,1] op_sel_hi:[1,1,1]
  v_rcp_f32 v206, v206
  v_rcp_f32 v207, v207
  v_pk_mul_f32 v[200:201], v[200:201], v[76:77]
  v_pk_mul_f32 v[202:203], v[202:203], v[78:79]
  v_pk_mul_f32 v[204:205], v[204:205], v[80:81]
  v_pk_mul_f32 v[206:207], v[206:207], v[82:83]
  v_cvt_pk_bf16_f32 v212, v200, v201
  v_cvt_pk_bf16_f32 v213, v202, v203
  v_cvt_pk_bf16_f32 v214, v204, v205
  v_cvt_pk_bf16_f32 v215, v206, v207
  buffer_store_dwordx4 v[212:215], v239, s[32:35], 0 offen offset:1024 sc1
  buffer_load_dword a108, v223, s[32:35], 0 offen offset:3072 sc1
  buffer_load_dword a109, v223, s[32:35], 0 offen offset:3200 sc1
  v_pk_mul_f32 v[192:193], v[72:73], v[72:73]
  v_pk_mul_f32 v[194:195], v[74:75], v[74:75]
  v_pk_mul_f32 v[196:197], v[84:85], v[84:85]
  v_pk_mul_f32 v[198:199], v[86:87], v[86:87]
  v_pk_fma_f32 v[192:193], v[192:193], v[24:25], v[24:25] op_sel:[0,0,1] op_sel_hi:[1,0,1]
  v_pk_fma_f32 v[194:195], v[194:195], v[24:25], v[24:25] op_sel:[0,0,1] op_sel_hi:[1,0,1]
  v_pk_fma_f32 v[196:197], v[196:197], v[28:29], v[28:29] op_sel:[0,0,1] op_sel_hi:[1,0,1]
  v_pk_fma_f32 v[198:199], v[198:199], v[28:29], v[28:29] op_sel:[0,0,1] op_sel_hi:[1,0,1]
  v_pk_mul_f32 v[192:193], v[192:193], v[72:73]
  v_exp_f32 v192, v192
  v_exp_f32 v193, v193
  v_pk_mul_f32 v[194:195], v[194:195], v[74:75]
  v_exp_f32 v194, v194
  v_exp_f32 v195, v195
  v_pk_mul_f32 v[196:197], v[196:197], v[84:85]
  v_exp_f32 v196, v196
  v_exp_f32 v197, v197
  v_pk_mul_f32 v[198:199], v[198:199], v[86:87]
  v_exp_f32 v198, v198
  v_exp_f32 v199, v199
  buffer_load_dword a110, v223, s[32:35], 0 offen offset:3328 sc1
  buffer_load_dword a111, v223, s[32:35], 0 offen offset:3456 sc1
  v_pk_fma_f32 v[192:193], v[192:193], v[16:17], v[16:17] op_sel:[0,1,1] op_sel_hi:[1,1,1]
  v_rcp_f32 v192, v192
  v_rcp_f32 v193, v193
  v_pk_fma_f32 v[194:195], v[194:195], v[16:17], v[16:17] op_sel:[0,1,1] op_sel_hi:[1,1,1]
  v_rcp_f32 v194, v194
  v_rcp_f32 v195, v195
  v_pk_fma_f32 v[196:197], v[196:197], v[26:27], v[26:27] op_sel:[0,1,1] op_sel_hi:[1,1,1]
  v_rcp_f32 v196, v196
  v_rcp_f32 v197, v197
  v_pk_fma_f32 v[198:199], v[198:199], v[26:27], v[26:27] op_sel:[0,1,1] op_sel_hi:[1,1,1]
  v_rcp_f32 v198, v198
  v_rcp_f32 v199, v199
  v_pk_mul_f32 v[192:193], v[192:193], v[72:73]
  v_pk_mul_f32 v[194:195], v[194:195], v[74:75]
  v_pk_mul_f32 v[196:197], v[196:197], v[84:85]
  v_pk_mul_f32 v[198:199], v[198:199], v[86:87]
  v_cvt_pk_bf16_f32 v208, v192, v193
  v_cvt_pk_bf16_f32 v209, v194, v195
  v_cvt_pk_bf16_f32 v210, v196, v197
  v_cvt_pk_bf16_f32 v211, v198, v199
  buffer_store_dwordx4 v[208:211], v239, s[32:35], 0 offen offset:2048 sc1
L_sp4:
  s_waitcnt lgkmcnt(0)
  s_xor_b64 s[8:9], s[8:9], s[6:7]
  s_xor_b64 s[10:11], s[10:11], s[6:7]
  s_or_b64 s[8:9], s[8:9], s[10:11]
  s_cbranch_scc0 L_sp4_done
  s_sub_u32 s46, s46, 1
  s_cmp_lt_i32 s46, 0
  s_cbranch_scc1 L_sp4_done
  s_load_dwordx4 s[8:11], s[32:33], s59 glc
  s_branch L_sp4
L_sp4_done:
  buffer_load_dwordx4 v[128:131], v252, s[32:35], s72 offen offset:0 sc1
  v_xor_b32 v24, v23, v21
  v_lshlrev_b32 v26, 4, v24
  v_lshrrev_b32 v24, 4, v0
  v_xor_b32 v24, v24, v21
  v_and_b32 v25, 15, v0
  v_lshl_add_u32 v24, v25, 4, v24
  v_lshl_add_u32 v224, v24, 4, s58
  v_lshlrev_b32 v24, 1, v21
  buffer_load_dwordx4 v[132:135], v252, s[32:35], s72 offen offset:1024 sc1
  v_xor_b32 v24, v24, v20
  v_lshlrev_b32 v24, 4, v24
  v_lshl_add_u32 v24, v20, 8, v24
  v_lshl_add_u32 v225, s38, 11, v24
  v_and_b32 v24, 15, v0
  v_lshl_add_u32 v24, v24, 7, v26
  v_bfe_u32 v26, v0, 4, 1
  v_lshl_add_u32 v24, v26, 3, v24
  buffer_load_dwordx4 v[136:139], v252, s[32:35], s72 offen offset:2048 sc1
  v_add_u32 v220, s58, v24
  v_xor_b32 v24, v21, v20
  v_lshl_add_u32 v24, v20, 3, v24
  s_mul_i32 s49, s39, 12
  s_add_u32 s49, s49, s40
  s_lshl_b32 s49, s49, 10
  v_lshl_add_u32 v219, v24, 4, s49
  v_bfe_u32 v24, v0, 1, 2
  buffer_load_dwordx4 v[140:143], v252, s[32:35], s72 offen offset:3072 sc1
  v_lshl_add_u32 v24, v22, 2, v24
  v_lshl_add_u32 v24, v24, 1, v23
  v_lshl_add_u32 v226, v24, 3, s58
  v_bfe_u32 v24, v0, 4, 2
  v_xor_b32 v24, v24, v0
  v_and_b32_e64 v24, 3, v24
  v_lshl_add_u32 v24, v20, 2, v24
  v_bfe_u32 v26, v0, 2, 1
  buffer_load_dwordx4 v[144:147], v252, s[32:35], s73 offen offset:0 sc1
  v_mul_u32_u24 v26, 12288, v26
  v_lshl_add_u32 v24, v24, 4, v26
  v_lshl_add_u32 v227, s38, 9, v24
  ds_write_b64 v220, v[8:9] offset:10240
  v_xor_b32 v16, 32, v220
  ds_write_b64 v16, v[10:11] offset:10240
  v_xor_b32 v16, 64, v220
  ds_write_b64 v16, v[12:13] offset:10240
  buffer_load_dwordx4 v[148:151], v252, s[32:35], s73 offen offset:1024 sc1
  v_xor_b32 v16, 96, v220
  ds_write_b64 v16, v[14:15] offset:10240
  v_mov_b32 v18, 0xbfb8aa3b
  v_fmamk_f32 v29, v216, 0x00000000, v217
  v_fmamk_f32 v30, v216, 0x3f800000, v217
  v_cos_f32 v192, v29
  v_sin_f32 v29, v29
  v_cos_f32 v193, v30
  buffer_load_dwordx4 v[152:155], v252, s[32:35], s73 offen offset:2048 sc1
  v_sin_f32 v30, v30
  v_cvt_pk_bf16_f32 v192, v192, v29
  v_cvt_pk_bf16_f32 v193, v193, v30
  v_fmamk_f32 v29, v216, 0x40000000, v217
  v_fmamk_f32 v30, v216, 0x40400000, v217
  v_cos_f32 v194, v29
  v_sin_f32 v29, v29
  v_cos_f32 v195, v30
  buffer_load_dwordx4 v[156:159], v252, s[32:35], s73 offen offset:3072 sc1
  v_sin_f32 v30, v30
  v_cvt_pk_bf16_f32 v194, v194, v29
  v_cvt_pk_bf16_f32 v195, v195, v30
  v_fmamk_f32 v29, v216, 0x41000000, v217
  v_fmamk_f32 v30, v216, 0x41100000, v217
  v_cos_f32 v196, v29
  v_sin_f32 v29, v29
  v_cos_f32 v197, v30
  buffer_load_dwordx4 v[160:163], v252, s[32:35], s74 offen offset:0 sc1
  v_sin_f32 v30, v30
  v_cvt_pk_bf16_f32 v196, v196, v29
  v_cvt_pk_bf16_f32 v197, v197, v30
  v_fmamk_f32 v29, v216, 0x41200000, v217
  v_fmamk_f32 v30, v216, 0x41300000, v217
  v_cos_f32 v198, v29
  v_sin_f32 v29, v29
  v_cos_f32 v199, v30
  buffer_load_dwordx4 v[164:167], v252, s[32:35], s74 offen offset:1024 sc1
  v_sin_f32 v30, v30
  v_cvt_pk_bf16_f32 v198, v198, v29
  v_cvt_pk_bf16_f32 v199, v199, v30
  v_fmamk_f32 v29, v216, 0x41800000, v217
  v_fmamk_f32 v30, v216, 0x41880000, v217
  v_cos_f32 v200, v29
  v_sin_f32 v29, v29
  v_cos_f32 v201, v30
  buffer_load_dwordx4 v[168:171], v252, s[32:35], s74 offen offset:2048 sc1
  v_sin_f32 v30, v30
  v_cvt_pk_bf16_f32 v200, v200, v29
  v_cvt_pk_bf16_f32 v201, v201, v30
  v_fmamk_f32 v29, v216, 0x41900000, v217
  v_fmamk_f32 v30, v216, 0x41980000, v217
  v_cos_f32 v202, v29
  v_sin_f32 v29, v29
  v_cos_f32 v203, v30
  buffer_load_dwordx4 v[172:175], v252, s[32:35], s74 offen offset:3072 sc1
  v_sin_f32 v30, v30
  v_cvt_pk_bf16_f32 v202, v202, v29
  v_cvt_pk_bf16_f32 v203, v203, v30
  v_fmamk_f32 v29, v216, 0x41c00000, v217
  v_fmamk_f32 v30, v216, 0x41c80000, v217
  v_cos_f32 v204, v29
  v_sin_f32 v29, v29
  v_cos_f32 v205, v30
  s_waitcnt vmcnt(10)
  v_mfma_f32_16x16x32_bf16 v[32:35], a[128:131], v[128:131], 0
  s_barrier
  buffer_store_dword v6, v1, s[32:35], s55 offen sc1
  buffer_load_dwordx4 v[176:179], v252, s[32:35], s75 offen offset:0 sc1
  v_mfma_f32_16x16x32_bf16 v[48:51], a[128:131], v[132:135], 0
  ds_read_b64_tr_b16 a[0:1], v244 offset:12288
  ds_read_b64_tr_b16 a[4:5], v245 offset:12288
  v_mfma_f32_16x16x32_bf16 v[36:39], a[132:135], v[128:131], 0
  v_sin_f32 v30, v30
  v_mfma_f32_16x16x32_bf16 v[52:55], a[132:135], v[132:135], 0
  ds_read_b64_tr_b16 a[8:9], v246 offset:12288
  ds_read_b64_tr_b16 a[12:13], v247 offset:12288
  v_mfma_f32_16x16x32_bf16 v[40:43], a[136:139], v[128:131], 0
  buffer_load_dwordx4 v[180:183], v252, s[32:35], s75 offen offset:1024 sc1
  v_cvt_pk_bf16_f32 v204, v204, v29
  v_mfma_f32_16x16x32_bf16 v[56:59], a[136:139], v[132:135], 0
  v_cvt_pk_bf16_f32 v205, v205, v30
  v_fmamk_f32 v29, v216, 0x41d00000, v217
  v_mfma_f32_16x16x32_bf16 v[44:47], a[140:143], v[128:131], 0
  ds_read_b64_tr_b16 a[2:3], v244 offset:14336
  ds_read_b64_tr_b16 a[6:7], v245 offset:14336
  v_mfma_f32_16x16x32_bf16 v[60:63], a[140:143], v[132:135], 0
  v_fmamk_f32 v30, v216, 0x41d80000, v217
  s_waitcnt vmcnt(11)
  v_mfma_f32_16x16x32_bf16 v[32:35], a[144:147], v[136:139], v[32:35]
  buffer_load_dwordx4 v[184:187], v252, s[32:35], s75 offen offset:2048 sc1
  v_mfma_f32_16x16x32_bf16 v[48:51], a[144:147], v[140:143], v[48:51]
  s_cmp_eq_u32 s2, 0
  s_cselect_b32 s47, 1048576, 0
  s_cselect_b32 s48, 0, 0x10000000
  v_mfma_f32_16x16x32_bf16 v[36:39], a[148:151], v[136:139], v[36:39]
  ds_read_b64_tr_b16 a[10:11], v246 offset:14336
  ds_read_b64_tr_b16 a[14:15], v247 offset:14336
  v_subrev_u32 v17, s47, v237
  v_mfma_f32_16x16x32_bf16 v[52:55], a[148:151], v[140:143], v[52:55]
  v_or_b32 v17, s48, v17
  v_mfma_f32_16x16x32_bf16 v[40:43], a[152:155], v[136:139], v[40:43]
  buffer_load_dwordx4 v[188:191], v252, s[32:35], s75 offen offset:3072 sc1
  buffer_store_dword v6, v17, s[32:35], 0 offen sc1
  v_mfma_f32_16x16x32_bf16 v[56:59], a[152:155], v[140:143], v[56:59]
  ds_read_b64_tr_b16 a[64:65], v240 offset:0
  ds_read_b64_tr_b16 a[68:69], v241 offset:0
  v_mfma_f32_16x16x32_bf16 v[44:47], a[156:159], v[136:139], v[44:47]
  v_cos_f32 v206, v29
  v_mfma_f32_16x16x32_bf16 v[60:63], a[156:159], v[140:143], v[60:63]
  ds_read_b64_tr_b16 a[72:73], v242 offset:0
  s_waitcnt vmcnt(12)
  v_mfma_f32_16x16x32_bf16 v[32:35], a[160:163], v[144:147], v[32:35]
  buffer_load_dwordx4 v[128:131], v253, s[32:35], s72 offen offset:0 sc1
  ds_read_b64_tr_b16 a[76:77], v243 offset:0
  v_mfma_f32_16x16x32_bf16 v[48:51], a[160:163], v[148:151], v[48:51]
  v_sin_f32 v29, v29
  v_mfma_f32_16x16x32_bf16 v[36:39], a[164:167], v[144:147], v[36:39]
  ds_read_b64_tr_b16 a[16:17], v240 offset:2048
  ds_read_b64_tr_b16 a[20:21], v241 offset:2048
  v_mfma_f32_16x16x32_bf16 v[52:55], a[164:167], v[148:151], v[52:55]
  v_cos_f32 v207, v30
  v_mfma_f32_16x16x32_bf16 v[40:43], a[168:171], v[144:147], v[40:43]
  buffer_load_dwordx4 v[132:135], v253, s[32:35], s72 offen offset:1024 sc1
  v_mfma_f32_16x16x32_bf16 v[56:59], a[168:171], v[148:151], v[56:59]
  ds_read_b64_tr_b16 a[24:25], v242 offset:2048
  ds_read_b64_tr_b16 a[28:29], v243 offset:2048
  v_mfma_f32_16x16x32_bf16 v[44:47], a[172:175], v[144:147], v[44:47]
  v_sin_f32 v30, v30
  v_mfma_f32_16x16x32_bf16 v[60:63], a[172:175], v[148:151], v[60:63]
  v_cvt_pk_bf16_f32 v206, v206, v29
  s_waitcnt vmcnt(12)
  v_mfma_f32_16x16x32_bf16 v[32:35], a[176:179], v[152:155], v[32:35]
  buffer_load_dwordx4 v[136:139], v253, s[32:35], s72 offen offset:2048 sc1
  ds_read_b64_tr_b16 a[18:19], v240 offset:4096
  v_mfma_f32_16x16x32_bf16 v[48:51], a[176:179], v[156:159], v[48:51]
  ds_read_b64_tr_b16 a[22:23], v241 offset:4096
  v_cvt_pk_bf16_f32 v207, v207, v30
  v_mfma_f32_16x16x32_bf16 v[36:39], a[180:183], v[152:155], v[36:39]
  v_mfma_f32_16x16x32_bf16 v[52:55], a[180:183], v[156:159], v[52:55]
  ds_read_b64_tr_b16 a[26:27], v242 offset:4096
  ds_read_b64_tr_b16 a[30:31], v243 offset:4096
  v_mfma_f32_16x16x32_bf16 v[40:43], a[184:187], v[152:155], v[40:43]
  buffer_load_dwordx4 v[140:143], v253, s[32:35], s72 offen offset:3072 sc1
  v_mfma_f32_16x16x32_bf16 v[56:59], a[184:187], v[156:159], v[56:59]
  v_mfma_f32_16x16x32_bf16 v[44:47], a[188:191], v[152:155], v[44:47]
  ds_read_b64_tr_b16 a[66:67], v240 offset:6144
  ds_read_b64_tr_b16 a[70:71], v241 offset:6144
  v_mfma_f32_16x16x32_bf16 v[60:63], a[188:191], v[156:159], v[60:63]
  s_waitcnt vmcnt(12)
  v_mfma_f32_16x16x32_bf16 v[32:35], a[192:195], v[160:163], v[32:35]
  buffer_load_dwordx4 v[144:147], v253, s[32:35], s73 offen offset:0 sc1
  v_mfma_f32_16x16x32_bf16 v[48:51], a[192:195], v[164:167], v[48:51]
  ds_read_b64_tr_b16 a[74:75], v242 offset:6144
  ds_read_b64_tr_b16 a[78:79], v243 offset:6144
  v_mfma_f32_16x16x32_bf16 v[36:39], a[196:199], v[160:163], v[36:39]
  v_mfma_f32_16x16x32_bf16 v[52:55], a[196:199], v[164:167], v[52:55]
  v_mfma_f32_16x16x32_bf16 v[40:43], a[200:203], v[160:163], v[40:43]
  buffer_load_dwordx4 v[148:151], v253, s[32:35], s73 offen offset:1024 sc1
  ds_read_b64_tr_b16 a[32:33], v240 offset:8192
  v_mfma_f32_16x16x32_bf16 v[56:59], a[200:203], v[164:167], v[56:59]
  ds_read_b64_tr_b16 a[36:37], v241 offset:8192
  v_mfma_f32_16x16x32_bf16 v[44:47], a[204:207], v[160:163], v[44:47]
  v_mfma_f32_16x16x32_bf16 v[60:63], a[204:207], v[164:167], v[60:63]
  ds_read_b64_tr_b16 a[40:41], v242 offset:8192
  s_waitcnt vmcnt(12)
  v_mfma_f32_16x16x32_bf16 v[32:35], a[208:211], v[168:171], v[32:35]
  buffer_load_dwordx4 v[152:155], v253, s[32:35], s73 offen offset:2048 sc1
  ds_read_b64_tr_b16 a[44:45], v243 offset:8192
  v_mfma_f32_16x16x32_bf16 v[48:51], a[208:211], v[172:175], v[48:51]
  v_mfma_f32_16x16x32_bf16 v[36:39], a[212:215], v[168:171], v[36:39]
  ds_read_b64_tr_b16 a[34:35], v244 offset:0
  ds_read_b64_tr_b16 a[38:39], v245 offset:0
  v_mfma_f32_16x16x32_bf16 v[52:55], a[212:215], v[172:175], v[52:55]
  v_mfma_f32_16x16x32_bf16 v[40:43], a[216:219], v[168:171], v[40:43]
  buffer_load_dwordx4 v[156:159], v253, s[32:35], s73 offen offset:3072 sc1
  v_mfma_f32_16x16x32_bf16 v[56:59], a[216:219], v[172:175], v[56:59]
  ds_read_b64_tr_b16 a[42:43], v246 offset:0
  ds_read_b64_tr_b16 a[46:47], v247 offset:0
  v_mfma_f32_16x16x32_bf16 v[44:47], a[220:223], v[168:171], v[44:47]
  v_mfma_f32_16x16x32_bf16 v[60:63], a[220:223], v[172:175], v[60:63]
  s_waitcnt vmcnt(11)
  v_mfma_f32_16x16x32_bf16 v[32:35], a[224:227], v[176:179], v[32:35]
  buffer_load_dwordx4 v[160:163], v253, s[32:35], s74 offen offset:0 sc1
  ds_read_b64_tr_b16 a[80:81], v244 offset:2048
  v_mfma_f32_16x16x32_bf16 v[48:51], a[224:227], v[180:183], v[48:51]
  ds_read_b64_tr_b16 a[84:85], v245 offset:2048
  v_mfma_f32_16x16x32_bf16 v[36:39], a[228:231], v[176:179], v[36:39]
  v_mfma_f32_16x16x32_bf16 v[52:55], a[228:231], v[180:183], v[52:55]
  ds_read_b64_tr_b16 a[88:89], v246 offset:2048
  ds_read_b64_tr_b16 a[92:93], v247 offset:2048
  v_mfma_f32_16x16x32_bf16 v[40:43], a[232:235], v[176:179], v[40:43]
  buffer_load_dwordx4 v[164:167], v253, s[32:35], s74 offen offset:1024 sc1
  s_load_dwordx4 s[8:11], s[32:33], s59 offset:16 glc
  v_mfma_f32_16x16x32_bf16 v[56:59], a[232:235], v[180:183], v[56:59]
  v_mfma_f32_16x16x32_bf16 v[44:47], a[236:239], v[176:179], v[44:47]
  ds_read_b64_tr_b16 a[82:83], v244 offset:4096
  ds_read_b64_tr_b16 a[86:87], v245 offset:4096
  v_mfma_f32_16x16x32_bf16 v[60:63], a[236:239], v[180:183], v[60:63]
  s_waitcnt vmcnt(11)
  v_mfma_f32_16x16x32_bf16 v[32:35], a[240:243], v[184:187], v[32:35]
  buffer_load_dwordx4 v[168:171], v253, s[32:35], s74 offen offset:2048 sc1
  v_mfma_f32_16x16x32_bf16 v[48:51], a[240:243], v[188:191], v[48:51]
  ds_read_b64_tr_b16 a[90:91], v246 offset:4096
  ds_read_b64_tr_b16 a[94:95], v247 offset:4096
  v_mfma_f32_16x16x32_bf16 v[36:39], a[244:247], v[184:187], v[36:39]
  v_mfma_f32_16x16x32_bf16 v[52:55], a[244:247], v[188:191], v[52:55]
  v_mfma_f32_16x16x32_bf16 v[40:43], a[248:251], v[184:187], v[40:43]
  buffer_load_dwordx4 v[172:175], v253, s[32:35], s74 offen offset:3072 sc1
  ds_read_b64_tr_b16 a[48:49], v244 offset:6144
  v_mfma_f32_16x16x32_bf16 v[56:59], a[248:251], v[188:191], v[56:59]
  ds_read_b64_tr_b16 a[52:53], v245 offset:6144
  v_mfma_f32_16x16x32_bf16 v[44:47], a[252:255], v[184:187], v[44:47]
  v_mfma_f32_16x16x32_bf16 v[60:63], a[252:255], v[188:191], v[60:63]
  ds_read_b64_tr_b16 a[56:57], v246 offset:6144
  s_waitcnt vmcnt(10)
  v_mfma_f32_16x16x32_bf16 v[64:67], a[128:131], v[128:131], 0
  buffer_load_dwordx4 v[176:179], v253, s[32:35], s75 offen offset:0 sc1
  ds_read_b64_tr_b16 a[60:61], v247 offset:6144
  v_mfma_f32_16x16x32_bf16 v[80:83], a[128:131], v[132:135], 0
  v_mfma_f32_16x16x32_bf16 v[68:71], a[132:135], v[128:131], 0
  v_mfma_f32_16x16x32_bf16 v[84:87], a[132:135], v[132:135], 0
  v_mfma_f32_16x16x32_bf16 v[72:75], a[136:139], v[128:131], 0
  buffer_load_dwordx4 v[180:183], v253, s[32:35], s75 offen offset:1024 sc1
  v_mfma_f32_16x16x32_bf16 v[88:91], a[136:139], v[132:135], 0
  v_mfma_f32_16x16x32_bf16 v[76:79], a[140:143], v[128:131], 0
  v_mfma_f32_16x16x32_bf16 v[92:95], a[140:143], v[132:135], 0
  s_waitcnt vmcnt(10)
  v_mfma_f32_16x16x32_bf16 v[64:67], a[144:147], v[136:139], v[64:67]
  buffer_load_dwordx4 v[184:187], v253, s[32:35], s75 offen offset:2048 sc1
  v_mfma_f32_16x16x32_bf16 v[80:83], a[144:147], v[140:143], v[80:83]
  v_mfma_f32_16x16x32_bf16 v[68:71], a[148:151], v[136:139], v[68:71]
  v_mfma_f32_16x16x32_bf16 v[84:87], a[148:151], v[140:143], v[84:87]
  v_mfma_f32_16x16x32_bf16 v[72:75], a[152:155], v[136:139], v[72:75]
  buffer_load_dwordx4 v[188:191], v253, s[32:35], s75 offen offset:3072 sc1
  v_mfma_f32_16x16x32_bf16 v[88:91], a[152:155], v[140:143], v[88:91]
  v_mfma_f32_16x16x32_bf16 v[76:79], a[156:159], v[136:139], v[76:79]
  v_mfma_f32_16x16x32_bf16 v[92:95], a[156:159], v[140:143], v[92:95]
  s_waitcnt vmcnt(10)
  v_mfma_f32_16x16x32_bf16 v[64:67], a[160:163], v[144:147], v[64:67]
  buffer_load_dwordx4 v250, s[24:27], s53 offen offset:2048 lds
  v_mfma_f32_16x16x32_bf16 v[80:83], a[160:163], v[148:151], v[80:83]
  v_mfma_f32_16x16x32_bf16 v[68:71], a[164:167], v[144:147], v[68:71]
  v_mfma_f32_16x16x32_bf16 v[84:87], a[164:167], v[148:151], v[84:87]
  v_mfma_f32_16x16x32_bf16 v[72:75], a[168:171], v[144:147], v[72:75]
  buffer_load_dwordx4 v251, s[24:27], s53 offen offset:3072 lds
  v_mfma_f32_16x16x32_bf16 v[88:91], a[168:171], v[148:151], v[88:91]
  v_mfma_f32_16x16x32_bf16 v[76:79], a[172:175], v[144:147], v[76:79]
  v_mfma_f32_16x16x32_bf16 v[92:95], a[172:175], v[148:151], v[92:95]
L_sp5:
  s_waitcnt lgkmcnt(0)
  s_xor_b64 s[8:9], s[8:9], s[6:7]
  s_xor_b64 s[10:11], s[10:11], s[6:7]
  s_or_b64 s[8:9], s[8:9], s[10:11]
  s_cbranch_scc0 L_sp5_done
  s_sub_u32 s46, s46, 1
  s_cmp_lt_i32 s46, 0
  s_cbranch_scc1 L_sp5_done
  s_load_dwordx4 s[8:11], s[32:33], s59 offset:16 glc
  s_branch L_sp5
L_sp5_done:
  buffer_load_dwordx4 v[128:131], v254, s[32:35], s76 offen offset:2048 sc1
  s_waitcnt vmcnt(11)
  v_mfma_f32_16x16x32_bf16 v[64:67], a[176:179], v[152:155], v[64:67]
  buffer_load_dwordx4 v[132:135], v254, s[32:35], s77 offen offset:2048 sc1
  v_xor_b32 v25, 64, v224
  v_mfma_f32_16x16x32_bf16 v[80:83], a[176:179], v[156:159], v[80:83]
  v_mov_b32 v28, v225
  v_xor_b32 v29, 16, v225
  v_mfma_f32_16x16x32_bf16 v[68:71], a[180:183], v[152:155], v[68:71]
  v_add_u32 v30, 49152, v28
  v_add_u32 v31, 49152, v29
  v_mfma_f32_16x16x32_bf16 v[84:87], a[180:183], v[156:159], v[84:87]
  buffer_load_dwordx4 v[136:139], v254, s[32:35], s78 offen offset:2048 sc1
  v_mfma_f32_16x16x32_bf16 v[72:75], a[184:187], v[152:155], v[72:75]
  v_mfma_f32_16x16x32_bf16 v[88:91], a[184:187], v[156:159], v[88:91]
  v_mfma_f32_16x16x32_bf16 v[76:79], a[188:191], v[152:155], v[76:79]
  v_mfma_f32_16x16x32_bf16 v[92:95], a[188:191], v[156:159], v[92:95]
  buffer_load_dwordx4 v[140:143], v254, s[32:35], s79 offen offset:2048 sc1
  s_waitcnt vmcnt(12)
  v_mfma_f32_16x16x32_bf16 v[64:67], a[192:195], v[160:163], v[64:67]
  v_mfma_f32_16x16x32_bf16 v[80:83], a[192:195], v[164:167], v[80:83]
  v_mfma_f32_16x16x32_bf16 v[68:71], a[196:199], v[160:163], v[68:71]
  v_mfma_f32_16x16x32_bf16 v[84:87], a[196:199], v[164:167], v[84:87]
  buffer_load_dwordx4 v[144:147], v254, s[32:35], s76 offen offset:0 sc1
  v_mfma_f32_16x16x32_bf16 v[72:75], a[200:203], v[160:163], v[72:75]
  v_mfma_f32_16x16x32_bf16 v[88:91], a[200:203], v[164:167], v[88:91]
  v_mfma_f32_16x16x32_bf16 v[76:79], a[204:207], v[160:163], v[76:79]
  v_mfma_f32_16x16x32_bf16 v[92:95], a[204:207], v[164:167], v[92:95]
  buffer_load_dwordx4 v[148:151], v254, s[32:35], s77 offen offset:0 sc1
  v_mfma_f32_32x32x16_bf16 v[96:111], a[96:99], v[192:195], 0
  v_mfma_f32_32x32x16_bf16 v[96:111], a[100:103], v[196:199], v[96:111]
  v_mfma_f32_32x32x16_bf16 v[96:111], a[104:107], v[200:203], v[96:111]
  v_mfma_f32_32x32x16_bf16 v[96:111], a[108:111], v[204:207], v[96:111]
  s_waitcnt vmcnt(12)
  v_mfma_f32_16x16x32_bf16 v[64:67], a[208:211], v[168:171], v[64:67]
  v_mfma_f32_16x16x32_bf16 v[80:83], a[208:211], v[172:175], v[80:83]
  v_mfma_f32_16x16x32_bf16 v[68:71], a[212:215], v[168:171], v[68:71]
  v_mfma_f32_16x16x32_bf16 v[84:87], a[212:215], v[172:175], v[84:87]
  buffer_load_dwordx4 v[152:155], v254, s[32:35], s78 offen offset:0 sc1
  s_nop 5
  v_cvt_pk_bf16_f32 v96, v96, v97
  v_mfma_f32_16x16x32_bf16 v[72:75], a[216:219], v[168:171], v[72:75]
L_pad6:
  s_cbranch_execz L_hopA
  v_cvt_pk_bf16_f32 v97, v98, v99
  v_xor_b32 v16, 0, v226
  v_mfma_f32_16x16x32_bf16 v[88:91], a[216:219], v[172:175], v[88:91]
  ds_write_b64 v16, v[96:97] offset:8192
  v_cvt_pk_bf16_f32 v100, v100, v101
  v_mfma_f32_16x16x32_bf16 v[76:79], a[220:223], v[168:171], v[76:79]
  v_cvt_pk_bf16_f32 v101, v102, v103
  v_xor_b32 v16, 16, v226
  v_mfma_f32_16x16x32_bf16 v[92:95], a[220:223], v[172:175], v[92:95]
  buffer_load_dwordx4 v[156:159], v254, s[32:35], s79 offen offset:0 sc1
  s_waitcnt vmcnt(12)
  v_mfma_f32_16x16x32_bf16 v[64:67], a[224:227], v[176:179], v[64:67]
  ds_write_b64 v16, v[100:101] offset:8192
  v_cvt_pk_bf16_f32 v104, v104, v105
  v_mfma_f32_16x16x32_bf16 v[80:83], a[224:227], v[180:183], v[80:83]
  v_cvt_pk_bf16_f32 v105, v106, v107
  v_xor_b32 v16, 32, v226
  v_mfma_f32_16x16x32_bf16 v[68:71], a[228:231], v[176:179], v[68:71]
  ds_write_b64 v16, v[104:105] offset:8192
  v_cvt_pk_bf16_f32 v108, v108, v109
  v_mfma_f32_16x16x32_bf16 v[84:87], a[228:231], v[180:183], v[84:87]
  buffer_load_dwordx4 v[160:163], v254, s[32:35], s76 offen offset:1024 sc1
  v_cvt_pk_bf16_f32 v109, v110, v111
  v_mfma_f32_16x16x32_bf16 v[72:75], a[232:235], v[176:179], v[72:75]
  v_xor_b32 v16, 48, v226
  v_mfma_f32_16x16x32_bf16 v[88:91], a[232:235], v[180:183], v[88:91]
  ds_write_b64 v16, v[108:109] offset:8192
  v_mfma_f32_16x16x32_bf16 v[76:79], a[236:239], v[176:179], v[76:79]
  v_mfma_f32_16x16x32_bf16 v[92:95], a[236:239], v[180:183], v[92:95]
  buffer_load_dwordx4 v[164:167], v254, s[32:35], s77 offen offset:1024 sc1
  s_waitcnt vmcnt(12)
  v_mfma_f32_16x16x32_bf16 v[64:67], a[240:243], v[184:187], v[64:67]
  s_waitcnt lgkmcnt(0)
  v_mfma_f32_16x16x32_bf16 v[80:83], a[240:243], v[188:191], v[80:83]
  s_barrier
  v_mfma_f32_16x16x32_bf16 v[68:71], a[244:247], v[184:187], v[68:71]
  ds_read_b128 v[112:115], v219 offset:34816
  ds_read_b128 v[124:127], v227 offset:32768
  v_mfma_f32_16x16x32_bf16 v[84:87], a[244:247], v[188:191], v[84:87]
  buffer_load_dwordx4 v[168:171], v254, s[32:35], s78 offen offset:1024 sc1
  v_lshlrev_b32 v8, 16, v120
  v_mfma_f32_16x16x32_bf16 v[72:75], a[248:251], v[184:187], v[72:75]
  s_waitcnt vmcnt(9)
  v_swap_b32 v130, v132
  v_mfma_f32_16x16x32_bf16 v[88:91], a[248:251], v[188:191], v[88:91]
  v_and_b32 v9, 0xffff0000, v120
  v_swap_b32 v131, v133
  v_mfma_f32_16x16x32_bf16 v[76:79], a[252:255], v[184:187], v[76:79]
  v_lshlrev_b32 v10, 16, v121
  v_and_b32 v11, 0xffff0000, v121
  v_mfma_f32_16x16x32_bf16 v[92:95], a[252:255], v[188:191], v[92:95]
  buffer_load_dwordx4 v[172:175], v254, s[32:35], s79 offen offset:1024 sc1
  v_mfma_f32_16x16x32_bf16 v[32:35], a[64:67], v[128:131], v[32:35]
  v_lshlrev_b32 v12, 16, v122
  v_and_b32 v13, 0xffff0000, v122
  v_mfma_f32_16x16x32_bf16 v[48:51], a[64:67], v[132:135], v[48:51]
  v_lshlrev_b32 v14, 16, v123
  v_and_b32 v15, 0xffff0000, v123
  v_mfma_f32_16x16x32_bf16 v[36:39], a[68:71], v[128:131], v[36:39]
  s_waitcnt lgkmcnt(0)
  v_lshlrev_b32 v96, 16, v112
  v_mfma_f32_16x16x32_bf16 v[52:55], a[68:71], v[132:135], v[52:55]
  buffer_load_dwordx4 v[176:179], v255, s[32:35], s76 offen offset:2048 sc1
  ds_read_b64_tr_b16 a[50:51], v244 offset:8192
  v_mfma_f32_16x16x32_bf16 v[40:43], a[72:75], v[128:131], v[40:43]
  s_waitcnt vmcnt(9)
  v_swap_b32 v138, v140
  v_mfma_f32_16x16x32_bf16 v[56:59], a[72:75], v[132:135], v[56:59]
  ds_read_b64_tr_b16 a[54:55], v245 offset:8192
  v_swap_b32 v139, v141
  v_mfma_f32_16x16x32_bf16 v[44:47], a[76:79], v[128:131], v[44:47]
  ds_read_b64_tr_b16 a[58:59], v246 offset:8192
  ds_read_b64_tr_b16 a[62:63], v247 offset:8192
  v_mfma_f32_16x16x32_bf16 v[60:63], a[76:79], v[132:135], v[60:63]
  buffer_load_dwordx4 v[180:183], v255, s[32:35], s77 offen offset:2048 sc1
  v_mfma_f32_16x16x32_bf16 v[32:35], a[80:83], v[136:139], v[32:35]
  v_and_b32 v97, 0xffff0000, v112
  v_lshlrev_b32 v98, 16, v113
  v_mfma_f32_16x16x32_bf16 v[48:51], a[80:83], v[140:143], v[48:51]
  v_and_b32 v99, 0xffff0000, v113
  v_lshlrev_b32 v100, 16, v114
  v_mfma_f32_16x16x32_bf16 v[36:39], a[84:87], v[136:139], v[36:39]
  v_and_b32 v101, 0xffff0000, v114
  v_lshlrev_b32 v102, 16, v115
  v_mfma_f32_16x16x32_bf16 v[52:55], a[84:87], v[140:143], v[52:55]
  buffer_load_dwordx4 v[184:187], v255, s[32:35], s78 offen offset:2048 sc1
  v_and_b32 v103, 0xffff0000, v115
  v_mfma_f32_16x16x32_bf16 v[40:43], a[88:91], v[136:139], v[40:43]
  v_lshlrev_b32 v104, 16, v124
  v_and_b32 v105, 0xffff0000, v124
  v_mfma_f32_16x16x32_bf16 v[56:59], a[88:91], v[140:143], v[56:59]
  v_lshlrev_b32 v106, 16, v125
  v_and_b32 v107, 0xffff0000, v125
  v_mfma_f32_16x16x32_bf16 v[44:47], a[92:95], v[136:139], v[44:47]
  v_lshlrev_b32 v108, 16, v126
  v_and_b32 v109, 0xffff0000, v126
  v_mfma_f32_16x16x32_bf16 v[60:63], a[92:95], v[140:143], v[60:63]
  buffer_load_dwordx4 v[188:191], v255, s[32:35], s79 offen offset:2048 sc1
  s_waitcnt vmcnt(10)
  v_mfma_f32_16x16x32_bf16 v[32:35], a[0:3], v[144:147], v[32:35]
  s_waitcnt lgkmcnt(0)
  v_lshlrev_b32 v110, 16, v127
  v_mfma_f32_16x16x32_bf16 v[32:35], a[16:19], v[148:151], v[32:35]
  v_and_b32 v111, 0xffff0000, v127
  v_mfma_f32_16x16x32_bf16 v[36:39], a[4:7], v[144:147], v[36:39]
  ds_read_b128 v[112:115], v219 offset:10240
  ds_read_b128 v[124:127], v227 offset:8192
  v_mfma_f32_16x16x32_bf16 v[36:39], a[20:23], v[148:151], v[36:39]
  buffer_load_dwordx4 v[128:131], v255, s[32:35], s76 offen offset:0 sc1
  v_lshlrev_b32 v244, 16, v116
  v_mfma_f32_16x16x32_bf16 v[40:43], a[8:11], v[144:147], v[40:43]
  v_and_b32 v245, 0xffff0000, v116
  v_lshlrev_b32 v246, 16, v117
  v_mfma_f32_16x16x32_bf16 v[40:43], a[24:27], v[148:151], v[40:43]
  v_and_b32 v247, 0xffff0000, v117
  v_lshlrev_b32 v248, 16, v118
  v_mfma_f32_16x16x32_bf16 v[44:47], a[12:15], v[144:147], v[44:47]
  v_and_b32 v249, 0xffff0000, v118
  v_lshlrev_b32 v250, 16, v119
  v_mfma_f32_16x16x32_bf16 v[44:47], a[28:31], v[148:151], v[44:47]
  buffer_load_dwordx4 v[132:135], v255, s[32:35], s77 offen offset:0 sc1
  s_waitcnt vmcnt(10)
  v_mfma_f32_16x16x32_bf16 v[32:35], a[32:35], v[152:155], v[32:35]
  v_and_b32 v251, 0xffff0000, v119
  s_waitcnt lgkmcnt(0)
  v_mfma_f32_16x16x32_bf16 v[32:35], a[48:51], v[156:159], v[32:35]
  v_lshlrev_b32 v228, 16, v112
  v_and_b32 v229, 0xffff0000, v112
  v_mfma_f32_16x16x32_bf16 v[36:39], a[36:39], v[152:155], v[36:39]
  v_lshlrev_b32 v230, 16, v113
  v_and_b32 v231, 0xffff0000, v113
  v_mfma_f32_16x16x32_bf16 v[36:39], a[52:55], v[156:159], v[36:39]
  buffer_load_dwordx4 v[136:139], v255, s[32:35], s78 offen offset:0 sc1
  v_lshlrev_b32 v232, 16, v114
  v_mfma_f32_16x16x32_bf16 v[40:43], a[40:43], v[152:155], v[40:43]
  v_and_b32 v233, 0xffff0000, v114
  v_lshlrev_b32 v234, 16, v115
  v_mfma_f32_16x16x32_bf16 v[40:43], a[56:59], v[156:159], v[40:43]
  v_and_b32 v235, 0xffff0000, v115
  v_lshlrev_b32 v236, 16, v124
  v_mfma_f32_16x16x32_bf16 v[44:47], a[44:47], v[152:155], v[44:47]
  v_and_b32 v237, 0xffff0000, v124
  v_lshlrev_b32 v238, 16, v125
  v_mfma_f32_16x16x32_bf16 v[44:47], a[60:63], v[156:159], v[44:47]
  buffer_load_dwordx4 v[140:143], v255, s[32:35], s79 offen offset:0 sc1
  s_waitcnt vmcnt(10)
  v_mfma_f32_16x16x32_bf16 v[48:51], a[0:3], v[160:163], v[48:51]
  v_and_b32 v239, 0xffff0000, v125
  v_lshlrev_b32 v240, 16, v126
  v_mfma_f32_16x16x32_bf16 v[48:51], a[16:19], v[164:167], v[48:51]
  v_and_b32 v241, 0xffff0000, v126
  v_lshlrev_b32 v242, 16, v127
  v_mfma_f32_16x16x32_bf16 v[52:55], a[4:7], v[160:163], v[52:55]
  ds_write_b128 v224, v[32:35] offset:0
  v_and_b32 v243, 0xffff0000, v127
  v_mfma_f32_16x16x32_bf16 v[52:55], a[20:23], v[164:167], v[52:55]
  buffer_load_dwordx4 v[144:147], v255, s[32:35], s76 offen offset:1024 sc1
  v_mfma_f32_16x16x32_bf16 v[56:59], a[8:11], v[160:163], v[56:59]
  v_mfma_f32_16x16x32_bf16 v[56:59], a[24:27], v[164:167], v[56:59]
  v_mfma_f32_16x16x32_bf16 v[60:63], a[12:15], v[160:163], v[60:63]
  ds_write_b128 v25, v[36:39] offset:0
  v_mfma_f32_16x16x32_bf16 v[60:63], a[28:31], v[164:167], v[60:63]
  buffer_load_dwordx4 v[148:151], v255, s[32:35], s77 offen offset:1024 sc1
  s_waitcnt vmcnt(10)
  v_mfma_f32_16x16x32_bf16 v[48:51], a[32:35], v[168:171], v[48:51]
  v_mfma_f32_16x16x32_bf16 v[48:51], a[48:51], v[172:175], v[48:51]
  v_mfma_f32_16x16x32_bf16 v[52:55], a[36:39], v[168:171], v[52:55]
  ds_write_b128 v224, v[40:43] offset:128
  v_mfma_f32_16x16x32_bf16 v[52:55], a[52:55], v[172:175], v[52:55]
  buffer_load_dwordx4 v[152:155], v255, s[32:35], s78 offen offset:1024 sc1
  v_mfma_f32_16x16x32_bf16 v[56:59], a[40:43], v[168:171], v[56:59]
  s_waitcnt vmcnt(9)
  v_swap_b32 v178, v180
  v_mfma_f32_16x16x32_bf16 v[56:59], a[56:59], v[172:175], v[56:59]
  v_swap_b32 v179, v181
  v_mfma_f32_16x16x32_bf16 v[60:63], a[44:47], v[168:171], v[60:63]
  ds_write_b128 v25, v[44:47] offset:128
  v_mfma_f32_16x16x32_bf16 v[60:63], a[60:63], v[172:175], v[60:63]
  buffer_load_dwordx4 v[156:159], v255, s[32:35], s79 offen offset:1024 sc1
  v_mfma_f32_16x16x32_bf16 v[64:67], a[64:67], v[176:179], v[64:67]
  v_mfma_f32_16x16x32_bf16 v[80:83], a[64:67], v[180:183], v[80:83]
  v_mfma_f32_16x16x32_bf16 v[68:71], a[68:71], v[176:179], v[68:71]
  ds_write_b128 v224, v[48:51] offset:4096
  v_mfma_f32_16x16x32_bf16 v[84:87], a[68:71], v[180:183], v[84:87]
  v_mfma_f32_16x16x32_bf16 v[72:75], a[72:75], v[176:179], v[72:75]
  s_waitcnt vmcnt(8)
  v_swap_b32 v186, v188
  v_mfma_f32_16x16x32_bf16 v[88:91], a[72:75], v[180:183], v[88:91]
  v_swap_b32 v187, v189
  v_mfma_f32_16x16x32_bf16 v[76:79], a[76:79], v[176:179], v[76:79]
  ds_write_b128 v25, v[52:55] offset:4096
  v_mfma_f32_16x16x32_bf16 v[92:95], a[76:79], v[180:183], v[92:95]
  v_mfma_f32_16x16x32_bf16 v[64:67], a[80:83], v[184:187], v[64:67]
  v_mfma_f32_16x16x32_bf16 v[80:83], a[80:83], v[188:191], v[80:83]
  v_mfma_f32_16x16x32_bf16 v[68:71], a[84:87], v[184:187], v[68:71]
  ds_write_b128 v224, v[56:59] offset:4224
  v_mfma_f32_16x16x32_bf16 v[84:87], a[84:87], v[188:191], v[84:87]
  v_mfma_f32_16x16x32_bf16 v[72:75], a[88:91], v[184:187], v[72:75]
  v_mfma_f32_16x16x32_bf16 v[88:91], a[88:91], v[188:191], v[88:91]
  v_mfma_f32_16x16x32_bf16 v[76:79], a[92:95], v[184:187], v[76:79]
  ds_write_b128 v25, v[60:63] offset:4224
  v_mfma_f32_16x16x32_bf16 v[92:95], a[92:95], v[188:191], v[92:95]
  s_waitcnt vmcnt(6)
  v_mfma_f32_16x16x32_bf16 v[64:67], a[0:3], v[128:131], v[64:67]
  v_mfma_f32_16x16x32_bf16 v[64:67], a[16:19], v[132:135], v[64:67]
  s_waitcnt lgkmcnt(0)
  v_mfma_f32_16x16x32_bf16 v[68:71], a[4:7], v[128:131], v[68:71]
  s_barrier
  v_mfma_f32_16x16x32_bf16 v[68:71], a[20:23], v[132:135], v[68:71]
  ds_read_b128 v[184:187], v28 offset:0
  ds_read_b128 v[188:191], v29 offset:0
  v_mfma_f32_16x16x32_bf16 v[72:75], a[8:11], v[128:131], v[72:75]
  ds_read_b128 v[192:195], v28 offset:12288
  ds_read_b128 v[196:199], v29 offset:12288
  v_mfma_f32_16x16x32_bf16 v[72:75], a[24:27], v[132:135], v[72:75]
  ds_read_b128 v[200:203], v28 offset:24576
  ds_read_b128 v[204:207], v29 offset:24576
  v_mfma_f32_16x16x32_bf16 v[76:79], a[12:15], v[128:131], v[76:79]
  ds_read_b128 v[208:211], v28 offset:36864
  ds_read_b128 v[212:215], v29 offset:36864
  v_mfma_f32_16x16x32_bf16 v[76:79], a[28:31], v[132:135], v[76:79]
  s_waitcnt lgkmcnt(6)
  s_waitcnt vmcnt(4)
  v_mfma_f32_16x16x32_bf16 v[64:67], a[32:35], v[136:139], v[64:67]
  v_add_f32 v228, v228, v184
  v_add_f32 v229, v229, v185
  v_mfma_f32_16x16x32_bf16 v[64:67], a[48:51], v[140:143], v[64:67]
  v_add_f32 v230, v230, v186
  v_add_f32 v231, v231, v187
  v_mfma_f32_16x16x32_bf16 v[68:71], a[36:39], v[136:139], v[68:71]
  v_add_f32 v232, v232, v188
  v_add_f32 v233, v233, v189
  v_mfma_f32_16x16x32_bf16 v[68:71], a[52:55], v[140:143], v[68:71]
  v_add_f32 v234, v234, v190
  v_add_f32 v235, v235, v191
  v_mfma_f32_16x16x32_bf16 v[72:75], a[40:43], v[136:139], v[72:75]
  s_waitcnt lgkmcnt(4)
  v_add_f32 v228, v228, v192
  v_mfma_f32_16x16x32_bf16 v[72:75], a[56:59], v[140:143], v[72:75]
  v_add_f32 v229, v229, v193
  v_add_f32 v230, v230, v194
  v_mfma_f32_16x16x32_bf16 v[76:79], a[44:47], v[136:139], v[76:79]
  v_add_f32 v231, v231, v195
  v_add_f32 v232, v232, v196
  v_mfma_f32_16x16x32_bf16 v[76:79], a[60:63], v[140:143], v[76:79]
  v_add_f32 v233, v233, v197
  s_waitcnt vmcnt(2)
  v_mfma_f32_16x16x32_bf16 v[80:83], a[0:3], v[144:147], v[80:83]
  v_add_f32 v234, v234, v198
  v_add_f32 v235, v235, v199
  v_mfma_f32_16x16x32_bf16 v[80:83], a[16:19], v[148:151], v[80:83]
  s_waitcnt lgkmcnt(2)
  v_add_f32 v228, v228, v200
  v_mfma_f32_16x16x32_bf16 v[84:87], a[4:7], v[144:147], v[84:87]
  ds_write_b128 v224, v[64:67] offset:49152
  v_add_f32 v229, v229, v201
  v_mfma_f32_16x16x32_bf16 v[84:87], a[20:23], v[148:151], v[84:87]
  v_add_f32 v230, v230, v202
  v_add_f32 v231, v231, v203
  v_mfma_f32_16x16x32_bf16 v[88:91], a[8:11], v[144:147], v[88:91]
  v_add_f32 v232, v232, v204
  v_add_f32 v233, v233, v205
  v_mfma_f32_16x16x32_bf16 v[88:91], a[24:27], v[148:151], v[88:91]
  v_add_f32 v234, v234, v206
  v_add_f32 v235, v235, v207
  v_mfma_f32_16x16x32_bf16 v[92:95], a[12:15], v[144:147], v[92:95]
  ds_write_b128 v25, v[68:71] offset:49152
  s_waitcnt lgkmcnt(2)
  v_mfma_f32_16x16x32_bf16 v[92:95], a[28:31], v[148:151], v[92:95]
  v_add_f32 v228, v228, v208
  s_waitcnt vmcnt(0)
  v_mfma_f32_16x16x32_bf16 v[80:83], a[32:35], v[152:155], v[80:83]
  v_add_f32 v229, v229, v209
  v_add_f32 v230, v230, v210
  v_mfma_f32_16x16x32_bf16 v[80:83], a[48:51], v[156:159], v[80:83]
  v_add_f32 v231, v231, v211
  v_add_f32 v232, v232, v212
  v_mfma_f32_16x16x32_bf16 v[84:87], a[36:39], v[152:155], v[84:87]
  ds_write_b128 v224, v[72:75] offset:49280
  v_add_f32 v233, v233, v213
  v_mfma_f32_16x16x32_bf16 v[84:87], a[52:55], v[156:159], v[84:87]
  v_add_f32 v234, v234, v214
  v_add_f32 v235, v235, v215
  v_mfma_f32_16x16x32_bf16 v[88:91], a[40:43], v[152:155], v[88:91]
  v_mul_f32 v184, v18, v228
  v_mfma_f32_16x16x32_bf16 v[88:91], a[56:59], v[156:159], v[88:91]
  v_exp_f32 v184, v184
  v_mfma_f32_16x16x32_bf16 v[92:95], a[44:47], v[152:155], v[92:95]
  ds_write_b128 v25, v[76:79] offset:49280
  v_mul_f32 v185, v18, v229
  v_mfma_f32_16x16x32_bf16 v[92:95], a[60:63], v[156:159], v[92:95]
  v_exp_f32 v185, v185
  v_mul_f32 v186, v18, v230
  v_exp_f32 v186, v186
  v_mul_f32 v187, v18, v231
  v_exp_f32 v187, v187
  v_mul_f32 v188, v18, v232
  v_exp_f32 v188, v188
  ds_write_b128 v224, v[80:83] offset:53248
  v_mul_f32 v189, v18, v233
  v_exp_f32 v189, v189
  v_mul_f32 v190, v18, v234
  v_exp_f32 v190, v190
  v_mul_f32 v191, v18, v235
  v_exp_f32 v191, v191
  v_pk_add_f32 v[184:185], v[184:185], 1.0 op_sel_hi:[1,0]
  ds_write_b128 v25, v[84:87] offset:53248
  v_rcp_f32 v184, v184
  v_rcp_f32 v185, v185
  v_pk_add_f32 v[186:187], v[186:187], 1.0 op_sel_hi:[1,0]
  v_rcp_f32 v186, v186
  v_rcp_f32 v187, v187
  v_pk_add_f32 v[188:189], v[188:189], 1.0 op_sel_hi:[1,0]
  v_rcp_f32 v188, v188
  v_rcp_f32 v189, v189
  ds_write_b128 v224, v[88:91] offset:53376
  v_pk_add_f32 v[190:191], v[190:191], 1.0 op_sel_hi:[1,0]
  v_rcp_f32 v190, v190
  v_rcp_f32_e64 v191, v191
  v_pk_mul_f32 v[184:185], v[184:185], v[228:229]
  v_pk_mul_f32 v[186:187], v[186:187], v[230:231]
  v_pk_mul_f32 v[188:189], v[188:189], v[232:233]
  v_pk_mul_f32 v[190:191], v[190:191], v[234:235]
  v_pk_fma_f32 v[184:185], v[184:185], v[236:237], v[244:245]
  ds_write_b128 v25, v[92:95] offset:53376
  v_pk_fma_f32 v[186:187], v[186:187], v[238:239], v[246:247]
  v_pk_fma_f32 v[188:189], v[188:189], v[240:241], v[248:249]
  v_pk_fma_f32 v[190:191], v[190:191], v[242:243], v[250:251]
  v_cvt_pk_bf16_f32 v228, v184, v185
  v_cvt_pk_bf16_f32 v229, v186, v187
  v_cvt_pk_bf16_f32 v230, v188, v189
  v_cvt_pk_bf16_f32 v231, v190, v191
  buffer_store_dwordx4 v[228:231], v221, s[28:31], 0 offen sc1
  s_waitcnt lgkmcnt(0)
  s_barrier
  ds_read_b128 v[32:35], v30 offset:0
  ds_read_b128 v[36:39], v31 offset:0
  ds_read_b128 v[40:43], v30 offset:12288
  ds_read_b128 v[44:47], v31 offset:12288
  ds_read_b128 v[48:51], v30 offset:24576
  ds_read_b128 v[52:55], v31 offset:24576
  ds_read_b128 v[56:59], v30 offset:36864
  ds_read_b128 v[60:63], v31 offset:36864
  s_waitcnt lgkmcnt(6)
  v_pk_add_f32 v[96:97], v[96:97], v[32:33]
  v_pk_add_f32 v[98:99], v[98:99], v[34:35]
  v_pk_add_f32 v[100:101], v[100:101], v[36:37]
  v_pk_add_f32 v[102:103], v[102:103], v[38:39]
  s_waitcnt lgkmcnt(4)
  v_pk_add_f32 v[96:97], v[96:97], v[40:41]
  v_pk_add_f32 v[98:99], v[98:99], v[42:43]
  v_pk_add_f32 v[100:101], v[100:101], v[44:45]
  v_pk_add_f32 v[102:103], v[102:103], v[46:47]
  s_waitcnt lgkmcnt(2)
  v_pk_add_f32 v[96:97], v[96:97], v[48:49]
  v_pk_add_f32 v[98:99], v[98:99], v[50:51]
  v_pk_add_f32 v[100:101], v[100:101], v[52:53]
  v_pk_add_f32 v[102:103], v[102:103], v[54:55]
  s_waitcnt lgkmcnt(0)
  v_pk_add_f32 v[96:97], v[96:97], v[56:57]
  v_pk_add_f32 v[98:99], v[98:99], v[58:59]
  v_pk_add_f32 v[100:101], v[100:101], v[60:61]
  v_pk_add_f32 v[102:103], v[102:103], v[62:63]
  v_pk_mul_f32 v[32:33], v[96:97], v[18:19] op_sel_hi:[1,0]
  v_exp_f32 v32, v32
  v_exp_f32 v33, v33
  v_pk_mul_f32 v[34:35], v[98:99], v[18:19] op_sel_hi:[1,0]
  v_exp_f32 v34, v34
  v_exp_f32 v35, v35
  v_pk_mul_f32 v[36:37], v[100:101], v[18:19] op_sel_hi:[1,0]
  v_exp_f32 v36, v36
  v_exp_f32 v37, v37
  v_pk_mul_f32 v[38:39], v[102:103], v[18:19] op_sel_hi:[1,0]
  v_exp_f32 v38, v38
  v_exp_f32 v39, v39
  v_pk_add_f32 v[32:33], v[32:33], 1.0 op_sel_hi:[1,0]
  v_rcp_f32 v32, v32
  v_rcp_f32 v33, v33
  v_pk_add_f32 v[34:35], v[34:35], 1.0 op_sel_hi:[1,0]
  v_rcp_f32 v34, v34
  v_rcp_f32 v35, v35
  v_pk_add_f32 v[36:37], v[36:37], 1.0 op_sel_hi:[1,0]
  v_rcp_f32 v36, v36
  v_rcp_f32 v37, v37
  v_pk_add_f32 v[38:39], v[38:39], 1.0 op_sel_hi:[1,0]
  v_rcp_f32 v38, v38
  v_rcp_f32 v39, v39
  v_pk_mul_f32 v[32:33], v[32:33], v[96:97]
  v_pk_mul_f32 v[34:35], v[34:35], v[98:99]
  v_pk_mul_f32 v[36:37], v[36:37], v[100:101]
  v_pk_mul_f32 v[38:39], v[38:39], v[102:103]
  v_pk_fma_f32 v[32:33], v[32:33], v[104:105], v[8:9]
  v_pk_fma_f32 v[34:35], v[34:35], v[106:107], v[10:11]
  v_pk_fma_f32 v[36:37], v[36:37], v[108:109], v[12:13]
  v_pk_fma_f32 v[38:39], v[38:39], v[110:111], v[14:15]
  v_cvt_pk_bf16_f32 v96, v32, v33
  v_cvt_pk_bf16_f32 v97, v34, v35
  v_cvt_pk_bf16_f32 v98, v36, v37
  v_cvt_pk_bf16_f32 v99, v38, v39
  buffer_store_dwordx4 v[96:99], v221, s[28:31], s0 offen sc1
L_end:
  s_endpgm
L_pad:
  .fill (32768 + 64 - (L_pad - L_pc)) / 4, 4, 0xbf810000
.section .rodata,"a"
.p2align 6
.amdhsa_kernel recurrent_scan__spectral_fnet__mixer_s_mlp__prompt_kernel
  .amdhsa_next_free_vgpr 512
  .amdhsa_next_free_sgpr 102
  .amdhsa_accum_offset 256
  .amdhsa_group_segment_fixed_size 0
  .amdhsa_kernarg_size 104
  .amdhsa_user_sgpr_count 2
  .amdhsa_user_sgpr_kernarg_segment_ptr 1
  .amdhsa_system_sgpr_workgroup_id_x 1
.end_amdhsa_kernel
```
